```python
import torch

def _softmax(x, axis=-1):
    return torch.softmax(x, dim=axis)
def _gelu(x):
    return torch.nn.functional.gelu(x, approximate="tanh")
def _silu(x):
    return torch.nn.functional.silu(x)
def _sigmoid(x):
    return torch.sigmoid(x)
def _layernorm(x, axis=-1, eps=1e-5):
    m = x.mean(dim=axis, keepdim=True)
    v = x.var(dim=axis, keepdim=True, unbiased=False)
    return (x - m) / torch.sqrt(v + eps)
def _scatter_add(tgt, idx, src, axis=0):
    return tgt.clone().index_add_(axis, idx, src)
def _segment_sum(src, seg, n):
    out = torch.zeros((n,) + src.shape[1:], dtype=src.dtype)
    return out.index_add_(0, seg, src)
def _pad(x, pw):
    flat = tuple(v for pair in reversed(pw) for v in pair)
    return torch.nn.functional.pad(x, flat)

kernel_name = 'standalone__linear_kernel_rfa__decode'

def setup_inputs():

    _w = (lambda a: (lambda t: t.to(torch.bfloat16) if t.is_floating_point() else t)(torch.as_tensor(a)))
    B, H, Sq, Sk, D, M = 1, 32, 1, 8192, 128, 16
    return {
        "q": _w((lambda *s: torch.randn(*s, dtype=torch.bfloat16) * 0.4)(B, H, Sq, D)),
        "k": _w((lambda *s: torch.randn(*s, dtype=torch.bfloat16) * 1.6)(B, H, Sk, D)),
        "v": _w((lambda *s: torch.randn(*s, dtype=torch.bfloat16) * 1.6)(B, H, Sk, D)),
        "omega": _w((lambda *s: torch.randn(*s, dtype=torch.bfloat16) * 1.6)(M, D)),
    }

def reference(q, k, v, omega):
    d = q.shape[-1]
    m = omega.shape[0]
    scale = float(d) ** -0.25
    qs = q * scale
    ks = k * scale
    q_proj = torch.einsum("bhsd,md->bhsm", qs, omega)
    k_proj = torch.einsum("bhsd,md->bhsm", ks, omega)
    q_sq = 0.5 * torch.einsum("bhsd,bhsd->bhs", qs, qs)[..., None]
    k_sq = 0.5 * torch.einsum("bhsd,bhsd->bhs", ks, ks)[..., None]
    inv_sqrt_m = float(m) ** -0.5
    phi_q = torch.exp(q_proj - q_sq) * inv_sqrt_m + 1e-6
    phi_k = torch.exp(k_proj - k_sq) * inv_sqrt_m + 1e-6
    kv = torch.einsum("bhsm,bhsd->bhmd", phi_k, v)
    z  = torch.einsum("bhsm->bhm", phi_k)
    num = torch.einsum("bhqm,bhmd->bhqd", phi_q, kv)
    den = torch.einsum("bhqm,bhm->bhq", phi_q, z)[..., None] + 1e-6
    return num / den
```

```asm
; @launch grid=(256,1,1) block=(512,1,1) lds=4160
.amdgcn_target "amdgcn-amd-amdhsa--gfx950"
.text
.globl standalone__linear_kernel_rfa__decode_kernel
.p2align 8
.type standalone__linear_kernel_rfa__decode_kernel,@function
standalone__linear_kernel_rfa__decode_kernel:
    s_load_dwordx4 s[4:7], s[0:1], 8
    s_load_dwordx2 s[8:9], s[0:1], 0
    s_load_dwordx4 s[12:15], s[0:1], 24
    s_load_dwordx2 s[16:17], s[0:1], 48
    s_cmp_ge_u32 s2, 256
    s_cbranch_scc1 L_end
    s_setprio 3
    v_lshrrev_b32 v9, 6, v0
    v_and_b32 v0, 63, v0
    s_and_b32 s19, s2, 31
    s_lshr_b32 s3, s2, 5
    v_readfirstlane_b32 s18, v9
    s_lshl_b32 s36, s19, 21
    s_lshl_b32 s37, s3, 18
    s_or_b32 s36, s36, s37
    s_bfe_u32 s37, s18, 0x20000
    s_lshl_b32 s37, s37, 15
    s_or_b32 s36, s36, s37
    s_bfe_u32 s37, s18, 0x10002
    s_lshl_b32 s37, s37, 14
    s_or_b32 s36, s36, s37
    v_lshrrev_b32 v10, 4, v0
    v_lshlrev_b32 v244, 4, v10
    v_and_b32 v11, 1, v0
    v_bfe_u32 v12, v0, 2, 2
    v_lshl_add_u32 v11, v11, 2, v12
    v_lshl_add_u32 v1, v11, 8, v244
    v_bfe_u32 v12, v0, 1, 1
    v_lshl_add_u32 v1, v12, 6, v1
    s_mov_b32 s41, 8192
    s_mov_b32 s42, 4096
    s_mov_b32 s43, 12288
    s_mov_b32 s44, 131072
    s_mov_b32 s45, 139264
    s_mov_b32 s46, 135168
    s_mov_b32 s47, 143360
    v_and_b32 v8, 15, v0
    v_lshlrev_b32 v2, 4, v0
    v_lshl_add_u32 v246, v8, 8, v244
    s_lshl_b32 s39, s19, 8
    s_mov_b32 s22, 0x24000
    s_mov_b32 s23, 0x00020000
    s_mov_b32 s30, 0x1000
    s_mov_b32 s31, 0x00020000
    s_mov_b32 s34, 0x100
    s_mov_b32 s35, 0x00020000
    s_waitcnt lgkmcnt(0)
    s_add_u32 s20, s4, s36
    s_addc_u32 s21, s5, 0
    s_mov_b32 s28, s12
    s_mov_b32 s29, s13
    s_add_u32 s32, s8, s39
    s_addc_u32 s33, s9, 0
    s_cmp_ge_u32 s18, 4
    s_cbranch_scc1 L_hi
    buffer_load_dwordx4 v[24:27], v1, s[20:23], 0 offen offset:0 nt
    buffer_load_dwordx4 v[28:31], v1, s[20:23], 0 offen offset:128 nt
    buffer_load_dwordx4 v[32:35], v1, s[20:23], s41 offen offset:0 nt
    buffer_load_dwordx4 v[36:39], v1, s[20:23], s41 offen offset:128 nt
    buffer_load_dwordx4 v[40:43], v1, s[20:23], s42 offen offset:0 nt
    buffer_load_dwordx4 v[44:47], v1, s[20:23], s42 offen offset:128 nt
    buffer_load_dwordx4 v[48:51], v1, s[20:23], s43 offen offset:0 nt
    buffer_load_dwordx4 v[52:55], v1, s[20:23], s43 offen offset:128 nt
    buffer_load_dwordx4 v[8:11], v246, s[28:31], 0 offen offset:0
    buffer_load_dwordx4 v[12:15], v246, s[28:31], 0 offen offset:64
    buffer_load_dwordx4 v[16:19], v246, s[28:31], 0 offen offset:128
    buffer_load_dwordx4 v[20:23], v246, s[28:31], 0 offen offset:192
    buffer_load_dwordx4 v[220:223], v244, s[32:35], 0 offen offset:0
    buffer_load_dwordx4 v[224:227], v244, s[32:35], 0 offen offset:64
    buffer_load_dwordx4 v[228:231], v244, s[32:35], 0 offen offset:128
    buffer_load_dwordx4 v[232:235], v244, s[32:35], 0 offen offset:192
    buffer_load_dwordx4 v[56:59], v1, s[20:23], 0 offen offset:2048 nt
    buffer_load_dwordx4 v[60:63], v1, s[20:23], 0 offen offset:2176 nt
    buffer_load_dwordx4 v[64:67], v1, s[20:23], s41 offen offset:2048 nt
    buffer_load_dwordx4 v[68:71], v1, s[20:23], s41 offen offset:2176 nt
    buffer_load_dwordx4 v[72:75], v1, s[20:23], s42 offen offset:2048 nt
    buffer_load_dwordx4 v[76:79], v1, s[20:23], s42 offen offset:2176 nt
    buffer_load_dwordx4 v[80:83], v1, s[20:23], s43 offen offset:2048 nt
    buffer_load_dwordx4 v[84:87], v1, s[20:23], s43 offen offset:2176 nt
    buffer_load_dwordx4 v[88:91], v1, s[20:23], s44 offen offset:0 nt
    buffer_load_dwordx4 v[92:95], v1, s[20:23], s44 offen offset:128 nt
    buffer_load_dwordx4 v[96:99], v1, s[20:23], s45 offen offset:0 nt
    buffer_load_dwordx4 v[100:103], v1, s[20:23], s45 offen offset:128 nt
    buffer_load_dwordx4 v[104:107], v1, s[20:23], s46 offen offset:0 nt
    buffer_load_dwordx4 v[108:111], v1, s[20:23], s46 offen offset:128 nt
    buffer_load_dwordx4 v[112:115], v1, s[20:23], s47 offen offset:0 nt
    buffer_load_dwordx4 v[116:119], v1, s[20:23], s47 offen offset:128 nt
    buffer_load_dwordx4 v[120:123], v1, s[20:23], s44 offen offset:2048 nt
    buffer_load_dwordx4 v[124:127], v1, s[20:23], s44 offen offset:2176 nt
    buffer_load_dwordx4 v[128:131], v1, s[20:23], s45 offen offset:2048 nt
    buffer_load_dwordx4 v[132:135], v1, s[20:23], s45 offen offset:2176 nt
    buffer_load_dwordx4 v[136:139], v1, s[20:23], s46 offen offset:2048 nt
    buffer_load_dwordx4 v[140:143], v1, s[20:23], s46 offen offset:2176 nt
    buffer_load_dwordx4 v[144:147], v1, s[20:23], s47 offen offset:2048 nt
    buffer_load_dwordx4 v[148:151], v1, s[20:23], s47 offen offset:2176 nt
    s_branch L_j
L_hi:
    s_cmp_lg_u32 s18, 7
    s_cbranch_scc1 L_noe
    s_lshl_b32 s37, s19, 7
    s_add_u32 s37, s37, 0x80000
    s_add_u32 s10, s16, s37
    s_addc_u32 s11, s17, 0
    s_load_dword s62, s[10:11], 0 glc
L_noe:
    buffer_load_dwordx4 v[24:27], v1, s[20:23], 0 offen offset:0 nt
    buffer_load_dwordx4 v[28:31], v1, s[20:23], 0 offen offset:128 nt
    buffer_load_dwordx4 v[32:35], v1, s[20:23], s41 offen offset:0 nt
    buffer_load_dwordx4 v[36:39], v1, s[20:23], s41 offen offset:128 nt
    buffer_load_dwordx4 v[8:11], v246, s[28:31], 0 offen offset:0
    buffer_load_dwordx4 v[12:15], v246, s[28:31], 0 offen offset:64
    buffer_load_dwordx4 v[16:19], v246, s[28:31], 0 offen offset:128
    buffer_load_dwordx4 v[20:23], v246, s[28:31], 0 offen offset:192
    buffer_load_dwordx4 v[220:223], v244, s[32:35], 0 offen offset:0
    buffer_load_dwordx4 v[224:227], v244, s[32:35], 0 offen offset:64
    buffer_load_dwordx4 v[228:231], v244, s[32:35], 0 offen offset:128
    buffer_load_dwordx4 v[232:235], v244, s[32:35], 0 offen offset:192
    buffer_load_dwordx4 v[40:43], v1, s[20:23], s42 offen offset:0 nt
    buffer_load_dwordx4 v[44:47], v1, s[20:23], s42 offen offset:128 nt
    buffer_load_dwordx4 v[48:51], v1, s[20:23], s43 offen offset:0 nt
    buffer_load_dwordx4 v[52:55], v1, s[20:23], s43 offen offset:128 nt
    buffer_load_dwordx4 v[56:59], v1, s[20:23], 0 offen offset:2048 nt
    buffer_load_dwordx4 v[60:63], v1, s[20:23], 0 offen offset:2176 nt
    buffer_load_dwordx4 v[64:67], v1, s[20:23], s41 offen offset:2048 nt
    buffer_load_dwordx4 v[68:71], v1, s[20:23], s41 offen offset:2176 nt
    buffer_load_dwordx4 v[72:75], v1, s[20:23], s42 offen offset:2048 nt
    buffer_load_dwordx4 v[76:79], v1, s[20:23], s42 offen offset:2176 nt
    buffer_load_dwordx4 v[80:83], v1, s[20:23], s43 offen offset:2048 nt
    buffer_load_dwordx4 v[84:87], v1, s[20:23], s43 offen offset:2176 nt
    buffer_load_dwordx4 v[88:91], v1, s[20:23], s44 offen offset:0 nt
    buffer_load_dwordx4 v[92:95], v1, s[20:23], s44 offen offset:128 nt
    buffer_load_dwordx4 v[96:99], v1, s[20:23], s45 offen offset:0 nt
    buffer_load_dwordx4 v[100:103], v1, s[20:23], s45 offen offset:128 nt
    buffer_load_dwordx4 v[104:107], v1, s[20:23], s46 offen offset:0 nt
    buffer_load_dwordx4 v[108:111], v1, s[20:23], s46 offen offset:128 nt
    buffer_load_dwordx4 v[112:115], v1, s[20:23], s47 offen offset:0 nt
    buffer_load_dwordx4 v[116:119], v1, s[20:23], s47 offen offset:128 nt
    buffer_load_dwordx4 v[120:123], v1, s[20:23], s44 offen offset:2048 nt
    buffer_load_dwordx4 v[124:127], v1, s[20:23], s44 offen offset:2176 nt
    buffer_load_dwordx4 v[128:131], v1, s[20:23], s45 offen offset:2048 nt
    buffer_load_dwordx4 v[132:135], v1, s[20:23], s45 offen offset:2176 nt
    buffer_load_dwordx4 v[136:139], v1, s[20:23], s46 offen offset:2048 nt
    buffer_load_dwordx4 v[140:143], v1, s[20:23], s46 offen offset:2176 nt
    buffer_load_dwordx4 v[144:147], v1, s[20:23], s47 offen offset:2048 nt
    buffer_load_dwordx4 v[148:151], v1, s[20:23], s47 offen offset:2176 nt
L_j:
    s_lshl_b32 s37, s19, 7
    s_add_u32 s37, s37, 0x80000
    s_add_u32 s10, s16, s37
    s_addc_u32 s11, s17, 0
    s_setprio 0
    s_add_u32 s24, s6, s36
    s_addc_u32 s25, s7, 0
    s_mov_b32 s26, 0x24000
    s_mov_b32 s27, 0x00020000
    s_mov_b32 s48, 0xffff0000
    s_mov_b32 s50, 0x3e9837f0
    s_mov_b32 s51, 0x3e9837f0
    s_mov_b32 s52, 0x3fb8aa3b
    s_mov_b32 s53, 0x3e800000
    s_mov_b32 s54, 0x05040100
    s_mov_b32 s55, 0x07060302
    v_mov_b32 v4, 0x358637bd
    v_mov_b32 v5, 1.0
    s_lshl_b32 s37, s18, 9
    v_lshl_add_u32 v6, v0, 3, s37
    v_bfe_u32 v246, v0, 3, 1
    v_lshlrev_b32 v246, 4, v246
    s_movk_i32 s37, 0x3f80
    v_lshlrev_b32 v246, v246, s37
    v_bfe_u32 v247, v0, 2, 1
    v_and_b32 v251, 1, v0
    v_lshl_add_u32 v247, v247, 1, v251
    v_lshrrev_b32 v251, 4, v0
    v_cmp_eq_u32 vcc, v247, v251
    s_nop 1
    v_cndmask_b32 v246, 0, v246, vcc
    v_and_b32 v251, 2, v0
    v_cmp_eq_u32 vcc, 0, v251
    s_nop 1
    v_cndmask_b32 v247, v246, 0, vcc
    v_cndmask_b32 v246, 0, v246, vcc
    v_mov_b32 v244, 0
    v_mov_b32 v245, 0
    v_mov_b32 v248, 0
    v_mov_b32 v249, 0
    v_lshrrev_b32 v1, 2, v0
    v_and_b32 v1, 2, v1
    v_bitop3_b32 v1, v1, v0, 3 bitop3:0x28
    v_mul_u32_u24 v1, 0x5555, v1
    s_lshl_b32 s56, s19, 14
    s_add_u32 s28, s16, s56
    s_addc_u32 s29, s17, 0
    s_mov_b32 s30, 0x4000
    s_mov_b32 s31, 0x00020000
    s_lshl_b32 s57, s3, 10
    s_add_u32 s32, s14, s39
    s_addc_u32 s33, s15, 0
    s_mov_b32 s34, 0x100
    s_mov_b32 s35, 0x00020000
    v_lshlrev_b32 v7, 3, v0
    s_lshl_b32 s37, s18, 2
    s_add_u32 s37, s37, 4096
    v_mov_b32 v250, s37
    s_cmp_ge_u32 s18, 4
    s_cbranch_scc1 L_hi2
    s_waitcnt vmcnt(24)
    s_branch L_j2
L_hi2:
    s_waitcnt vmcnt(28)
L_j2:
    v_lshlrev_b32 v184, 16, v220
    v_lshlrev_b32 v186, 16, v221
    v_lshlrev_b32 v188, 16, v222
    v_lshlrev_b32 v190, 16, v223
    v_and_b32 v185, s48, v220
    v_and_b32 v187, s48, v221
    v_and_b32 v189, s48, v222
    v_and_b32 v191, s48, v223
    v_pk_mul_f32 v[184:185], v[184:185], s[50:51]
    v_pk_mul_f32 v[186:187], v[186:187], s[50:51]
    v_pk_mul_f32 v[188:189], v[188:189], s[50:51]
    v_pk_mul_f32 v[190:191], v[190:191], s[50:51]
    v_cvt_pk_bf16_f32 v220, v184, v185
    v_cvt_pk_bf16_f32 v221, v186, v187
    v_cvt_pk_bf16_f32 v222, v188, v189
    v_cvt_pk_bf16_f32 v223, v190, v191
    v_lshlrev_b32 v184, 16, v224
    v_lshlrev_b32 v186, 16, v225
    v_lshlrev_b32 v188, 16, v226
    v_lshlrev_b32 v190, 16, v227
    v_and_b32 v185, s48, v224
    v_and_b32 v187, s48, v225
    v_and_b32 v189, s48, v226
    v_and_b32 v191, s48, v227
    v_dot2_f32_bf16 v192, v220, v220, 0
    v_dot2_f32_bf16 v192, v221, v221, v192
    v_dot2_f32_bf16 v192, v222, v222, v192
    v_dot2_f32_bf16 v192, v223, v223, v192
    v_pk_mul_f32 v[184:185], v[184:185], s[50:51]
    v_pk_mul_f32 v[186:187], v[186:187], s[50:51]
    v_pk_mul_f32 v[188:189], v[188:189], s[50:51]
    v_pk_mul_f32 v[190:191], v[190:191], s[50:51]
    v_cvt_pk_bf16_f32 v224, v184, v185
    v_cvt_pk_bf16_f32 v225, v186, v187
    v_cvt_pk_bf16_f32 v226, v188, v189
    v_cvt_pk_bf16_f32 v227, v190, v191
    v_lshlrev_b32 v184, 16, v228
    v_lshlrev_b32 v186, 16, v229
    v_lshlrev_b32 v188, 16, v230
    v_lshlrev_b32 v190, 16, v231
    v_and_b32 v185, s48, v228
    v_and_b32 v187, s48, v229
    v_and_b32 v189, s48, v230
    v_and_b32 v191, s48, v231
    v_dot2_f32_bf16 v192, v224, v224, v192
    v_dot2_f32_bf16 v192, v225, v225, v192
    v_dot2_f32_bf16 v192, v226, v226, v192
    v_dot2_f32_bf16 v192, v227, v227, v192
    v_pk_mul_f32 v[184:185], v[184:185], s[50:51]
    v_pk_mul_f32 v[186:187], v[186:187], s[50:51]
    v_pk_mul_f32 v[188:189], v[188:189], s[50:51]
    v_pk_mul_f32 v[190:191], v[190:191], s[50:51]
    v_cvt_pk_bf16_f32 v228, v184, v185
    v_cvt_pk_bf16_f32 v229, v186, v187
    v_cvt_pk_bf16_f32 v230, v188, v189
    v_cvt_pk_bf16_f32 v231, v190, v191
    v_lshlrev_b32 v184, 16, v232
    v_lshlrev_b32 v186, 16, v233
    v_lshlrev_b32 v188, 16, v234
    v_lshlrev_b32 v190, 16, v235
    v_and_b32 v185, s48, v232
    v_and_b32 v187, s48, v233
    v_and_b32 v189, s48, v234
    v_and_b32 v191, s48, v235
    v_dot2_f32_bf16 v192, v228, v228, v192
    v_dot2_f32_bf16 v192, v229, v229, v192
    v_dot2_f32_bf16 v192, v230, v230, v192
    v_dot2_f32_bf16 v192, v231, v231, v192
    v_pk_mul_f32 v[184:185], v[184:185], s[50:51]
    v_pk_mul_f32 v[186:187], v[186:187], s[50:51]
    v_pk_mul_f32 v[188:189], v[188:189], s[50:51]
    v_pk_mul_f32 v[190:191], v[190:191], s[50:51]
    v_cvt_pk_bf16_f32 v232, v184, v185
    v_cvt_pk_bf16_f32 v233, v186, v187
    v_cvt_pk_bf16_f32 v234, v188, v189
    v_cvt_pk_bf16_f32 v235, v190, v191
    v_dot2_f32_bf16 v192, v232, v232, v192
    v_dot2_f32_bf16 v192, v233, v233, v192
    v_dot2_f32_bf16 v192, v234, v234, v192
    v_dot2_f32_bf16 v192, v235, v235, v192
    v_mfma_f32_16x16x32_bf16 v[240:243], v[8:11], v[220:223], 0
    v_mfma_f32_16x16x32_bf16 v[240:243], v[12:15], v[224:227], v[240:243]
    v_mfma_f32_16x16x32_bf16 v[240:243], v[16:19], v[228:231], v[240:243]
    v_mfma_f32_16x16x32_bf16 v[240:243], v[20:23], v[232:235], v[240:243]
    v_mfma_f32_16x16x4_f32 v[204:207], v192, v5, 0
    s_nop 6
    v_cvt_pk_bf16_f32 v240, 0, v240
    v_cvt_pk_bf16_f32 v241, 0, v241
    v_cvt_pk_bf16_f32 v242, 0, v242
    v_cvt_pk_bf16_f32 v243, 0, v243
    v_cvt_pk_bf16_f32 v204, 0, v204
    v_cvt_pk_bf16_f32 v205, 0, v205
    v_cvt_pk_bf16_f32 v206, 0, v206
    v_cvt_pk_bf16_f32 v207, 0, v207
    v_fma_f32 v240, v204, -0.5, v240
    v_fma_f32 v241, v205, -0.5, v241
    v_fma_f32 v242, v206, -0.5, v242
    v_fma_f32 v243, v207, -0.5, v243
    v_cvt_pk_bf16_f32 v240, 0, v240
    v_cvt_pk_bf16_f32 v241, 0, v241
    v_cvt_pk_bf16_f32 v242, 0, v242
    v_cvt_pk_bf16_f32 v243, 0, v243
    v_mul_f32 v240, s52, v240
    v_mul_f32 v241, s52, v241
    v_mul_f32 v242, s52, v242
    v_mul_f32 v243, s52, v243
    v_exp_f32 v240, v240
    v_exp_f32 v241, v241
    v_exp_f32 v242, v242
    v_exp_f32 v243, v243
    v_cvt_pk_bf16_f32 v240, 0, v240
    v_cvt_pk_bf16_f32 v241, 0, v241
    v_cvt_pk_bf16_f32 v242, 0, v242
    v_cvt_pk_bf16_f32 v243, 0, v243
    v_fma_f32 v240, v240, s53, v4
    v_fma_f32 v241, v241, s53, v4
    v_fma_f32 v242, v242, s53, v4
    v_fma_f32 v243, v243, s53, v4
    v_cvt_pk_bf16_f32 v240, 0, v240
    v_cvt_pk_bf16_f32 v241, 0, v241
    v_cvt_pk_bf16_f32 v242, 0, v242
    v_cvt_pk_bf16_f32 v243, 0, v243
    s_waitcnt vmcnt(24)
    v_lshlrev_b32 v184, 16, v24
    v_lshlrev_b32 v186, 16, v25
    v_lshlrev_b32 v188, 16, v26
    v_lshlrev_b32 v190, 16, v27
    v_and_b32 v185, s48, v24
    v_and_b32 v187, s48, v25
    v_and_b32 v189, s48, v26
    v_and_b32 v191, s48, v27
    v_pk_mul_f32 v[184:185], v[184:185], s[50:51]
    v_pk_mul_f32 v[186:187], v[186:187], s[50:51]
    v_pk_mul_f32 v[188:189], v[188:189], s[50:51]
    v_pk_mul_f32 v[190:191], v[190:191], s[50:51]
    v_cvt_pk_bf16_f32 v24, v184, v185
    v_cvt_pk_bf16_f32 v25, v186, v187
    v_cvt_pk_bf16_f32 v26, v188, v189
    v_cvt_pk_bf16_f32 v27, v190, v191
    v_lshlrev_b32 v184, 16, v28
    v_lshlrev_b32 v186, 16, v29
    v_lshlrev_b32 v188, 16, v30
    v_lshlrev_b32 v190, 16, v31
    v_and_b32 v185, s48, v28
    v_and_b32 v187, s48, v29
    v_and_b32 v189, s48, v30
    v_and_b32 v191, s48, v31
    v_dot2_f32_bf16 v176, v24, v24, 0
    v_dot2_f32_bf16 v176, v25, v25, v176
    v_dot2_f32_bf16 v176, v26, v26, v176
    v_dot2_f32_bf16 v176, v27, v27, v176
    v_mfma_f32_16x16x32_bf16 v[154:157], v[24:27], v[8:11], 0
    v_pk_mul_f32 v[184:185], v[184:185], s[50:51]
    v_pk_mul_f32 v[186:187], v[186:187], s[50:51]
    v_pk_mul_f32 v[188:189], v[188:189], s[50:51]
    v_pk_mul_f32 v[190:191], v[190:191], s[50:51]
    v_cvt_pk_bf16_f32 v28, v184, v185
    v_cvt_pk_bf16_f32 v29, v186, v187
    v_cvt_pk_bf16_f32 v30, v188, v189
    v_cvt_pk_bf16_f32 v31, v190, v191
    v_lshlrev_b32 v184, 16, v32
    v_lshlrev_b32 v186, 16, v33
    v_lshlrev_b32 v188, 16, v34
    v_lshlrev_b32 v190, 16, v35
    v_and_b32 v185, s48, v32
    v_and_b32 v187, s48, v33
    v_and_b32 v189, s48, v34
    v_and_b32 v191, s48, v35
    v_dot2_f32_bf16 v176, v28, v28, v176
    v_dot2_f32_bf16 v176, v29, v29, v176
    v_dot2_f32_bf16 v176, v30, v30, v176
    v_dot2_f32_bf16 v176, v31, v31, v176
    v_mfma_f32_16x16x32_bf16 v[154:157], v[28:31], v[16:19], v[154:157]
    v_pk_mul_f32 v[184:185], v[184:185], s[50:51]
    v_pk_mul_f32 v[186:187], v[186:187], s[50:51]
    v_pk_mul_f32 v[188:189], v[188:189], s[50:51]
    v_pk_mul_f32 v[190:191], v[190:191], s[50:51]
    v_cvt_pk_bf16_f32 v32, v184, v185
    v_cvt_pk_bf16_f32 v33, v186, v187
    v_cvt_pk_bf16_f32 v34, v188, v189
    v_cvt_pk_bf16_f32 v35, v190, v191
    v_lshlrev_b32 v184, 16, v36
    v_lshlrev_b32 v186, 16, v37
    v_lshlrev_b32 v188, 16, v38
    v_lshlrev_b32 v190, 16, v39
    v_and_b32 v185, s48, v36
    v_and_b32 v187, s48, v37
    v_and_b32 v189, s48, v38
    v_and_b32 v191, s48, v39
    v_dot2_f32_bf16 v177, v32, v32, 0
    v_dot2_f32_bf16 v177, v33, v33, v177
    v_dot2_f32_bf16 v177, v34, v34, v177
    v_dot2_f32_bf16 v177, v35, v35, v177
    v_mfma_f32_16x16x32_bf16 v[160:163], v[32:35], v[8:11], 0
    v_mfma_f32_16x16x4_f32 v[194:197], v176, v5, 0
    v_mfma_f32_16x16x32_bf16 v[152:155], v[24:27], v[12:15], v[152:155]
    v_mfma_f32_16x16x32_bf16 v[152:155], v[28:31], v[20:23], v[152:155]
    v_pk_mul_f32 v[184:185], v[184:185], s[50:51]
    v_pk_mul_f32 v[186:187], v[186:187], s[50:51]
    v_pk_mul_f32 v[188:189], v[188:189], s[50:51]
    v_pk_mul_f32 v[190:191], v[190:191], s[50:51]
    v_cvt_pk_bf16_f32 v36, v184, v185
    v_cvt_pk_bf16_f32 v37, v186, v187
    v_cvt_pk_bf16_f32 v38, v188, v189
    v_cvt_pk_bf16_f32 v39, v190, v191
    v_lshlrev_b32 v184, 16, v40
    v_lshlrev_b32 v186, 16, v41
    v_lshlrev_b32 v188, 16, v42
    v_lshlrev_b32 v190, 16, v43
    v_and_b32 v185, s48, v40
    v_and_b32 v187, s48, v41
    v_and_b32 v189, s48, v42
    v_and_b32 v191, s48, v43
    v_dot2_f32_bf16 v177, v36, v36, v177
    v_dot2_f32_bf16 v177, v37, v37, v177
    v_dot2_f32_bf16 v177, v38, v38, v177
    v_dot2_f32_bf16 v177, v39, v39, v177
    v_mfma_f32_16x16x32_bf16 v[160:163], v[36:39], v[16:19], v[160:163]
    v_mfma_f32_16x16x4_f32 v[192:195], v176, v5, v[192:195]
    v_pk_mul_f32 v[184:185], v[184:185], s[50:51]
    v_pk_mul_f32 v[186:187], v[186:187], s[50:51]
    v_pk_mul_f32 v[188:189], v[188:189], s[50:51]
    v_pk_mul_f32 v[190:191], v[190:191], s[50:51]
    v_cvt_pk_bf16_f32 v40, v184, v185
    v_cvt_pk_bf16_f32 v41, v186, v187
    v_cvt_pk_bf16_f32 v42, v188, v189
    v_cvt_pk_bf16_f32 v43, v190, v191
    v_lshlrev_b32 v184, 16, v44
    v_lshlrev_b32 v186, 16, v45
    v_lshlrev_b32 v188, 16, v46
    v_lshlrev_b32 v190, 16, v47
    v_and_b32 v185, s48, v44
    v_and_b32 v187, s48, v45
    v_and_b32 v189, s48, v46
    v_and_b32 v191, s48, v47
    v_dot2_f32_bf16 v178, v40, v40, 0
    v_dot2_f32_bf16 v178, v41, v41, v178
    v_dot2_f32_bf16 v178, v42, v42, v178
    v_dot2_f32_bf16 v178, v43, v43, v178
    v_mfma_f32_16x16x32_bf16 v[166:169], v[40:43], v[8:11], 0
    v_mfma_f32_16x16x4_f32 v[200:203], v177, v5, 0
    v_mfma_f32_16x16x32_bf16 v[158:161], v[32:35], v[12:15], v[158:161]
    v_mfma_f32_16x16x32_bf16 v[158:161], v[36:39], v[20:23], v[158:161]
    v_pk_mul_f32 v[184:185], v[184:185], s[50:51]
    v_pk_mul_f32 v[186:187], v[186:187], s[50:51]
    v_pk_mul_f32 v[188:189], v[188:189], s[50:51]
    v_pk_mul_f32 v[190:191], v[190:191], s[50:51]
    v_cvt_pk_bf16_f32 v44, v184, v185
    v_cvt_pk_bf16_f32 v45, v186, v187
    v_cvt_pk_bf16_f32 v46, v188, v189
    v_cvt_pk_bf16_f32 v47, v190, v191
    v_lshlrev_b32 v184, 16, v48
    v_lshlrev_b32 v186, 16, v49
    v_lshlrev_b32 v188, 16, v50
    v_lshlrev_b32 v190, 16, v51
    v_and_b32 v185, s48, v48
    v_and_b32 v187, s48, v49
    v_and_b32 v189, s48, v50
    v_and_b32 v191, s48, v51
    v_dot2_f32_bf16 v178, v44, v44, v178
    v_dot2_f32_bf16 v178, v45, v45, v178
    v_dot2_f32_bf16 v178, v46, v46, v178
    v_dot2_f32_bf16 v178, v47, v47, v178
    v_mfma_f32_16x16x32_bf16 v[166:169], v[44:47], v[16:19], v[166:169]
    v_mfma_f32_16x16x4_f32 v[198:201], v177, v5, v[198:201]
    v_pk_mul_f32 v[184:185], v[184:185], s[50:51]
    v_pk_mul_f32 v[186:187], v[186:187], s[50:51]
    v_pk_mul_f32 v[188:189], v[188:189], s[50:51]
    v_pk_mul_f32 v[190:191], v[190:191], s[50:51]
    v_cvt_pk_bf16_f32 v48, v184, v185
    v_cvt_pk_bf16_f32 v49, v186, v187
    v_cvt_pk_bf16_f32 v50, v188, v189
    v_cvt_pk_bf16_f32 v51, v190, v191
    v_lshlrev_b32 v184, 16, v52
    v_lshlrev_b32 v186, 16, v53
    v_lshlrev_b32 v188, 16, v54
    v_lshlrev_b32 v190, 16, v55
    v_and_b32 v185, s48, v52
    v_and_b32 v187, s48, v53
    v_and_b32 v189, s48, v54
    v_and_b32 v191, s48, v55
    v_dot2_f32_bf16 v179, v48, v48, 0
    v_dot2_f32_bf16 v179, v49, v49, v179
    v_dot2_f32_bf16 v179, v50, v50, v179
    v_dot2_f32_bf16 v179, v51, v51, v179
    v_mfma_f32_16x16x32_bf16 v[172:175], v[48:51], v[8:11], 0
    v_mfma_f32_16x16x4_f32 v[206:209], v178, v5, 0
    v_mfma_f32_16x16x32_bf16 v[164:167], v[40:43], v[12:15], v[164:167]
    v_mfma_f32_16x16x32_bf16 v[164:167], v[44:47], v[20:23], v[164:167]
    v_pk_mul_f32 v[184:185], v[184:185], s[50:51]
    v_pk_mul_f32 v[186:187], v[186:187], s[50:51]
    v_pk_mul_f32 v[188:189], v[188:189], s[50:51]
    v_pk_mul_f32 v[190:191], v[190:191], s[50:51]
    v_cvt_pk_bf16_f32 v52, v184, v185
    v_cvt_pk_bf16_f32 v53, v186, v187
    v_cvt_pk_bf16_f32 v54, v188, v189
    v_cvt_pk_bf16_f32 v55, v190, v191
    v_dot2_f32_bf16 v179, v52, v52, v179
    v_dot2_f32_bf16 v179, v53, v53, v179
    v_dot2_f32_bf16 v179, v54, v54, v179
    v_dot2_f32_bf16 v179, v55, v55, v179
    v_mfma_f32_16x16x32_bf16 v[172:175], v[52:55], v[16:19], v[172:175]
    v_mfma_f32_16x16x4_f32 v[204:207], v178, v5, v[204:207]
    s_nop 0
    v_mfma_f32_16x16x4_f32 v[212:215], v179, v5, 0
    v_cvt_pk_bf16_f32 v154, 0, v154
    v_cvt_pk_bf16_f32 v155, 0, v155
    v_cvt_pk_bf16_f32 v160, 0, v160
    v_cvt_pk_bf16_f32 v161, 0, v161
    v_cvt_pk_bf16_f32 v194, 0, v194
    v_cvt_pk_bf16_f32 v195, 0, v195
    v_cvt_pk_bf16_f32 v200, 0, v200
    v_cvt_pk_bf16_f32 v201, 0, v201
    v_mfma_f32_16x16x32_bf16 v[170:173], v[48:51], v[12:15], v[170:173]
    v_mfma_f32_16x16x32_bf16 v[170:173], v[52:55], v[20:23], v[170:173]
    v_mfma_f32_16x16x4_f32 v[210:213], v179, v5, v[210:213]
    v_cvt_pk_bf16_f32 v166, 0, v166
    v_cvt_pk_bf16_f32 v167, 0, v167
    v_cvt_pk_bf16_f32 v206, 0, v206
    v_cvt_pk_bf16_f32 v207, 0, v207
    v_fma_f32 v154, v194, -0.5, v154
    v_fma_f32 v155, v195, -0.5, v155
    v_fma_f32 v160, v200, -0.5, v160
    v_fma_f32 v161, v201, -0.5, v161
    v_fma_f32 v166, v206, -0.5, v166
    v_fma_f32 v167, v207, -0.5, v167
    v_cvt_pk_bf16_f32 v154, 0, v154
    v_cvt_pk_bf16_f32 v155, 0, v155
    v_cvt_pk_bf16_f32 v160, 0, v160
    v_cvt_pk_bf16_f32 v161, 0, v161
    v_cvt_pk_bf16_f32 v166, 0, v166
    v_cvt_pk_bf16_f32 v167, 0, v167
    v_cvt_pk_bf16_f32 v172, 0, v172
    v_cvt_pk_bf16_f32 v173, 0, v173
    v_cvt_pk_bf16_f32 v212, 0, v212
    v_cvt_pk_bf16_f32 v213, 0, v213
    v_fma_f32 v172, v212, -0.5, v172
    v_fma_f32 v173, v213, -0.5, v173
    v_cvt_pk_bf16_f32 v172, 0, v172
    v_cvt_pk_bf16_f32 v173, 0, v173
    v_mul_f32 v154, s52, v154
    v_mul_f32 v155, s52, v155
    v_mul_f32 v160, s52, v160
    v_mul_f32 v161, s52, v161
    v_mul_f32 v166, s52, v166
    v_mul_f32 v167, s52, v167
    v_mul_f32 v172, s52, v172
    v_mul_f32 v173, s52, v173
    v_exp_f32 v154, v154
    v_exp_f32 v155, v155
    v_exp_f32 v160, v160
    v_exp_f32 v161, v161
    v_exp_f32 v166, v166
    v_exp_f32 v167, v167
    v_exp_f32 v172, v172
    v_exp_f32 v173, v173
    v_cvt_pk_bf16_f32 v154, 0, v154
    v_cvt_pk_bf16_f32 v155, 0, v155
    v_cvt_pk_bf16_f32 v160, 0, v160
    v_cvt_pk_bf16_f32 v161, 0, v161
    v_cvt_pk_bf16_f32 v166, 0, v166
    v_cvt_pk_bf16_f32 v167, 0, v167
    v_cvt_pk_bf16_f32 v172, 0, v172
    v_cvt_pk_bf16_f32 v173, 0, v173
    v_fma_f32 v154, v154, s53, v4
    v_fma_f32 v155, v155, s53, v4
    v_fma_f32 v160, v160, s53, v4
    v_fma_f32 v161, v161, s53, v4
    v_fma_f32 v166, v166, s53, v4
    v_fma_f32 v167, v167, s53, v4
    v_fma_f32 v172, v172, s53, v4
    v_fma_f32 v173, v173, s53, v4
    v_cvt_pk_bf16_f32 v232, v154, v155
    v_cvt_pk_bf16_f32 v233, v160, v161
    v_cvt_pk_bf16_f32 v234, v166, v167
    v_cvt_pk_bf16_f32 v235, v172, v173
    s_nop 1
    v_mfma_f32_16x16x32_bf16 v[160:163], v[232:235], v[246:249], 0
    v_mfma_f32_16x16x32_bf16 v[164:167], v[232:235], v[244:247], 0
    s_nop 6
    v_mul_f32 v152, v240, v160
    v_mul_f32 v153, v240, v164
    v_fmac_f32 v152, v241, v161
    v_fmac_f32 v153, v241, v165
    v_fmac_f32 v152, v242, v162
    v_fmac_f32 v153, v242, v166
    v_fmac_f32 v152, v243, v163
    v_fmac_f32 v153, v243, v167
    v_add_f32 v251, v152, v153
    v_mfma_f32_16x16x4_f32 v[168:171], v152, v5, 0
    v_mfma_f32_16x16x4_f32 v[172:175], v153, v5, 0
    s_nop 8
    v_cvt_pk_bf16_f32 v160, 0, v168
    v_cvt_pk_bf16_f32 v161, 0, v169
    v_cvt_pk_bf16_f32 v162, 0, v170
    v_cvt_pk_bf16_f32 v163, 0, v171
    v_cvt_pk_bf16_f32 v164, 0, v172
    v_cvt_pk_bf16_f32 v165, 0, v173
    v_cvt_pk_bf16_f32 v166, 0, v174
    v_cvt_pk_bf16_f32 v167, 0, v175
    v_pk_add_f32 v[160:161], v[168:169], v[160:161] neg_lo:[0,1] neg_hi:[0,1]
    v_pk_add_f32 v[162:163], v[170:171], v[162:163] neg_lo:[0,1] neg_hi:[0,1]
    v_pk_add_f32 v[164:165], v[172:173], v[164:165] neg_lo:[0,1] neg_hi:[0,1]
    v_pk_add_f32 v[166:167], v[174:175], v[166:167] neg_lo:[0,1] neg_hi:[0,1]
    v_cvt_pk_bf16_f32 v220, v160, v168
    v_cvt_pk_bf16_f32 v221, v161, v169
    v_cvt_pk_bf16_f32 v222, v162, v170
    v_cvt_pk_bf16_f32 v223, v163, v171
    v_cvt_pk_bf16_f32 v224, v164, v172
    v_cvt_pk_bf16_f32 v225, v165, v173
    v_cvt_pk_bf16_f32 v226, v166, v174
    v_cvt_pk_bf16_f32 v227, v167, v175
    s_waitcnt vmcnt(16)
    v_lshlrev_b32 v184, 16, v56
    v_lshlrev_b32 v186, 16, v57
    v_lshlrev_b32 v188, 16, v58
    v_lshlrev_b32 v190, 16, v59
    v_and_b32 v185, s48, v56
    v_and_b32 v187, s48, v57
    v_and_b32 v189, s48, v58
    v_and_b32 v191, s48, v59
    v_pk_mul_f32 v[184:185], v[184:185], s[50:51]
    v_pk_mul_f32 v[186:187], v[186:187], s[50:51]
    v_pk_mul_f32 v[188:189], v[188:189], s[50:51]
    v_pk_mul_f32 v[190:191], v[190:191], s[50:51]
    v_cvt_pk_bf16_f32 v56, v184, v185
    v_cvt_pk_bf16_f32 v57, v186, v187
    v_cvt_pk_bf16_f32 v58, v188, v189
    v_cvt_pk_bf16_f32 v59, v190, v191
    v_lshlrev_b32 v184, 16, v60
    v_lshlrev_b32 v186, 16, v61
    v_lshlrev_b32 v188, 16, v62
    v_lshlrev_b32 v190, 16, v63
    v_and_b32 v185, s48, v60
    v_and_b32 v187, s48, v61
    v_and_b32 v189, s48, v62
    v_and_b32 v191, s48, v63
    v_dot2_f32_bf16 v176, v56, v56, 0
    v_dot2_f32_bf16 v176, v57, v57, v176
    v_dot2_f32_bf16 v176, v58, v58, v176
    v_dot2_f32_bf16 v176, v59, v59, v176
    v_mfma_f32_16x16x32_bf16 v[154:157], v[56:59], v[8:11], 0
    v_pk_mul_f32 v[184:185], v[184:185], s[50:51]
    v_pk_mul_f32 v[186:187], v[186:187], s[50:51]
    v_pk_mul_f32 v[188:189], v[188:189], s[50:51]
    v_pk_mul_f32 v[190:191], v[190:191], s[50:51]
    v_cvt_pk_bf16_f32 v60, v184, v185
    v_cvt_pk_bf16_f32 v61, v186, v187
    v_cvt_pk_bf16_f32 v62, v188, v189
    v_cvt_pk_bf16_f32 v63, v190, v191
    v_lshlrev_b32 v184, 16, v64
    v_lshlrev_b32 v186, 16, v65
    v_lshlrev_b32 v188, 16, v66
    v_lshlrev_b32 v190, 16, v67
    v_and_b32 v185, s48, v64
    v_and_b32 v187, s48, v65
    v_and_b32 v189, s48, v66
    v_and_b32 v191, s48, v67
    v_dot2_f32_bf16 v176, v60, v60, v176
    v_dot2_f32_bf16 v176, v61, v61, v176
    v_dot2_f32_bf16 v176, v62, v62, v176
    v_dot2_f32_bf16 v176, v63, v63, v176
    v_mfma_f32_16x16x32_bf16 v[154:157], v[60:63], v[16:19], v[154:157]
    v_pk_mul_f32 v[184:185], v[184:185], s[50:51]
    v_pk_mul_f32 v[186:187], v[186:187], s[50:51]
    v_pk_mul_f32 v[188:189], v[188:189], s[50:51]
    v_pk_mul_f32 v[190:191], v[190:191], s[50:51]
    v_cvt_pk_bf16_f32 v64, v184, v185
    v_cvt_pk_bf16_f32 v65, v186, v187
    v_cvt_pk_bf16_f32 v66, v188, v189
    v_cvt_pk_bf16_f32 v67, v190, v191
    v_lshlrev_b32 v184, 16, v68
    v_lshlrev_b32 v186, 16, v69
    v_lshlrev_b32 v188, 16, v70
    v_lshlrev_b32 v190, 16, v71
    v_and_b32 v185, s48, v68
    v_and_b32 v187, s48, v69
    v_and_b32 v189, s48, v70
    v_and_b32 v191, s48, v71
    v_dot2_f32_bf16 v177, v64, v64, 0
    v_dot2_f32_bf16 v177, v65, v65, v177
    v_dot2_f32_bf16 v177, v66, v66, v177
    v_dot2_f32_bf16 v177, v67, v67, v177
    v_mfma_f32_16x16x32_bf16 v[160:163], v[64:67], v[8:11], 0
    v_mfma_f32_16x16x4_f32 v[194:197], v176, v5, 0
    v_mfma_f32_16x16x32_bf16 v[152:155], v[56:59], v[12:15], v[152:155]
    v_mfma_f32_16x16x32_bf16 v[152:155], v[60:63], v[20:23], v[152:155]
    v_pk_mul_f32 v[184:185], v[184:185], s[50:51]
    v_pk_mul_f32 v[186:187], v[186:187], s[50:51]
    v_pk_mul_f32 v[188:189], v[188:189], s[50:51]
    v_pk_mul_f32 v[190:191], v[190:191], s[50:51]
    v_cvt_pk_bf16_f32 v68, v184, v185
    v_cvt_pk_bf16_f32 v69, v186, v187
    v_cvt_pk_bf16_f32 v70, v188, v189
    v_cvt_pk_bf16_f32 v71, v190, v191
    v_lshlrev_b32 v184, 16, v72
    v_lshlrev_b32 v186, 16, v73
    v_lshlrev_b32 v188, 16, v74
    v_lshlrev_b32 v190, 16, v75
    v_and_b32 v185, s48, v72
    v_and_b32 v187, s48, v73
    v_and_b32 v189, s48, v74
    v_and_b32 v191, s48, v75
    v_dot2_f32_bf16 v177, v68, v68, v177
    v_dot2_f32_bf16 v177, v69, v69, v177
    v_dot2_f32_bf16 v177, v70, v70, v177
    v_dot2_f32_bf16 v177, v71, v71, v177
    v_mfma_f32_16x16x32_bf16 v[160:163], v[68:71], v[16:19], v[160:163]
    v_mfma_f32_16x16x4_f32 v[192:195], v176, v5, v[192:195]
    v_pk_mul_f32 v[184:185], v[184:185], s[50:51]
    v_pk_mul_f32 v[186:187], v[186:187], s[50:51]
    v_pk_mul_f32 v[188:189], v[188:189], s[50:51]
    v_pk_mul_f32 v[190:191], v[190:191], s[50:51]
    v_cvt_pk_bf16_f32 v72, v184, v185
    v_cvt_pk_bf16_f32 v73, v186, v187
    v_cvt_pk_bf16_f32 v74, v188, v189
    v_cvt_pk_bf16_f32 v75, v190, v191
    v_lshlrev_b32 v184, 16, v76
    v_lshlrev_b32 v186, 16, v77
    v_lshlrev_b32 v188, 16, v78
    v_lshlrev_b32 v190, 16, v79
    v_and_b32 v185, s48, v76
    v_and_b32 v187, s48, v77
    v_and_b32 v189, s48, v78
    v_and_b32 v191, s48, v79
    v_dot2_f32_bf16 v178, v72, v72, 0
    v_dot2_f32_bf16 v178, v73, v73, v178
    v_dot2_f32_bf16 v178, v74, v74, v178
    v_dot2_f32_bf16 v178, v75, v75, v178
    v_mfma_f32_16x16x32_bf16 v[166:169], v[72:75], v[8:11], 0
    v_mfma_f32_16x16x4_f32 v[200:203], v177, v5, 0
    v_mfma_f32_16x16x32_bf16 v[158:161], v[64:67], v[12:15], v[158:161]
    v_mfma_f32_16x16x32_bf16 v[158:161], v[68:71], v[20:23], v[158:161]
    v_pk_mul_f32 v[184:185], v[184:185], s[50:51]
    v_pk_mul_f32 v[186:187], v[186:187], s[50:51]
    v_pk_mul_f32 v[188:189], v[188:189], s[50:51]
    v_pk_mul_f32 v[190:191], v[190:191], s[50:51]
    v_cvt_pk_bf16_f32 v76, v184, v185
    v_cvt_pk_bf16_f32 v77, v186, v187
    v_cvt_pk_bf16_f32 v78, v188, v189
    v_cvt_pk_bf16_f32 v79, v190, v191
    v_lshlrev_b32 v184, 16, v80
    v_lshlrev_b32 v186, 16, v81
    v_lshlrev_b32 v188, 16, v82
    v_lshlrev_b32 v190, 16, v83
    v_and_b32 v185, s48, v80
    v_and_b32 v187, s48, v81
    v_and_b32 v189, s48, v82
    v_and_b32 v191, s48, v83
    v_dot2_f32_bf16 v178, v76, v76, v178
    v_dot2_f32_bf16 v178, v77, v77, v178
    v_dot2_f32_bf16 v178, v78, v78, v178
    v_dot2_f32_bf16 v178, v79, v79, v178
    v_mfma_f32_16x16x32_bf16 v[166:169], v[76:79], v[16:19], v[166:169]
    v_mfma_f32_16x16x4_f32 v[198:201], v177, v5, v[198:201]
    v_pk_mul_f32 v[184:185], v[184:185], s[50:51]
    v_pk_mul_f32 v[186:187], v[186:187], s[50:51]
    v_pk_mul_f32 v[188:189], v[188:189], s[50:51]
    v_pk_mul_f32 v[190:191], v[190:191], s[50:51]
    v_cvt_pk_bf16_f32 v80, v184, v185
    v_cvt_pk_bf16_f32 v81, v186, v187
    v_cvt_pk_bf16_f32 v82, v188, v189
    v_cvt_pk_bf16_f32 v83, v190, v191
    v_lshlrev_b32 v184, 16, v84
    v_lshlrev_b32 v186, 16, v85
    v_lshlrev_b32 v188, 16, v86
    v_lshlrev_b32 v190, 16, v87
    v_and_b32 v185, s48, v84
    v_and_b32 v187, s48, v85
    v_and_b32 v189, s48, v86
    v_and_b32 v191, s48, v87
    v_dot2_f32_bf16 v179, v80, v80, 0
    v_dot2_f32_bf16 v179, v81, v81, v179
    v_dot2_f32_bf16 v179, v82, v82, v179
    v_dot2_f32_bf16 v179, v83, v83, v179
    v_mfma_f32_16x16x32_bf16 v[172:175], v[80:83], v[8:11], 0
    v_mfma_f32_16x16x4_f32 v[206:209], v178, v5, 0
    v_mfma_f32_16x16x32_bf16 v[164:167], v[72:75], v[12:15], v[164:167]
    v_mfma_f32_16x16x32_bf16 v[164:167], v[76:79], v[20:23], v[164:167]
    v_pk_mul_f32 v[184:185], v[184:185], s[50:51]
    v_pk_mul_f32 v[186:187], v[186:187], s[50:51]
    v_pk_mul_f32 v[188:189], v[188:189], s[50:51]
    v_pk_mul_f32 v[190:191], v[190:191], s[50:51]
    v_cvt_pk_bf16_f32 v84, v184, v185
    v_cvt_pk_bf16_f32 v85, v186, v187
    v_cvt_pk_bf16_f32 v86, v188, v189
    v_cvt_pk_bf16_f32 v87, v190, v191
    v_dot2_f32_bf16 v179, v84, v84, v179
    v_dot2_f32_bf16 v179, v85, v85, v179
    v_dot2_f32_bf16 v179, v86, v86, v179
    v_dot2_f32_bf16 v179, v87, v87, v179
    v_mfma_f32_16x16x32_bf16 v[172:175], v[84:87], v[16:19], v[172:175]
    v_mfma_f32_16x16x4_f32 v[204:207], v178, v5, v[204:207]
    s_nop 0
    v_mfma_f32_16x16x4_f32 v[212:215], v179, v5, 0
    v_cvt_pk_bf16_f32 v154, 0, v154
    v_cvt_pk_bf16_f32 v155, 0, v155
    v_cvt_pk_bf16_f32 v160, 0, v160
    v_cvt_pk_bf16_f32 v161, 0, v161
    v_cvt_pk_bf16_f32 v194, 0, v194
    v_cvt_pk_bf16_f32 v195, 0, v195
    v_cvt_pk_bf16_f32 v200, 0, v200
    v_cvt_pk_bf16_f32 v201, 0, v201
    v_mfma_f32_16x16x32_bf16 v[170:173], v[80:83], v[12:15], v[170:173]
    v_mfma_f32_16x16x32_bf16 v[170:173], v[84:87], v[20:23], v[170:173]
    v_mfma_f32_16x16x4_f32 v[210:213], v179, v5, v[210:213]
    v_cvt_pk_bf16_f32 v166, 0, v166
    v_cvt_pk_bf16_f32 v167, 0, v167
    v_cvt_pk_bf16_f32 v206, 0, v206
    v_cvt_pk_bf16_f32 v207, 0, v207
    v_fma_f32 v154, v194, -0.5, v154
    v_fma_f32 v155, v195, -0.5, v155
    v_fma_f32 v160, v200, -0.5, v160
    v_fma_f32 v161, v201, -0.5, v161
    v_fma_f32 v166, v206, -0.5, v166
    v_fma_f32 v167, v207, -0.5, v167
    v_cvt_pk_bf16_f32 v154, 0, v154
    v_cvt_pk_bf16_f32 v155, 0, v155
    v_cvt_pk_bf16_f32 v160, 0, v160
    v_cvt_pk_bf16_f32 v161, 0, v161
    v_cvt_pk_bf16_f32 v166, 0, v166
    v_cvt_pk_bf16_f32 v167, 0, v167
    v_cvt_pk_bf16_f32 v172, 0, v172
    v_cvt_pk_bf16_f32 v173, 0, v173
    v_cvt_pk_bf16_f32 v212, 0, v212
    v_cvt_pk_bf16_f32 v213, 0, v213
    v_fma_f32 v172, v212, -0.5, v172
    v_fma_f32 v173, v213, -0.5, v173
    v_cvt_pk_bf16_f32 v172, 0, v172
    v_cvt_pk_bf16_f32 v173, 0, v173
    v_mul_f32 v154, s52, v154
    v_mul_f32 v155, s52, v155
    v_mul_f32 v160, s52, v160
    v_mul_f32 v161, s52, v161
    v_mul_f32 v166, s52, v166
    v_mul_f32 v167, s52, v167
    v_mul_f32 v172, s52, v172
    v_mul_f32 v173, s52, v173
    v_exp_f32 v154, v154
    v_exp_f32 v155, v155
    v_exp_f32 v160, v160
    v_exp_f32 v161, v161
    v_exp_f32 v166, v166
    v_exp_f32 v167, v167
    v_exp_f32 v172, v172
    v_exp_f32 v173, v173
    v_cvt_pk_bf16_f32 v154, 0, v154
    v_cvt_pk_bf16_f32 v155, 0, v155
    v_cvt_pk_bf16_f32 v160, 0, v160
    v_cvt_pk_bf16_f32 v161, 0, v161
    v_cvt_pk_bf16_f32 v166, 0, v166
    v_cvt_pk_bf16_f32 v167, 0, v167
    v_cvt_pk_bf16_f32 v172, 0, v172
    v_cvt_pk_bf16_f32 v173, 0, v173
    v_fma_f32 v154, v154, s53, v4
    v_fma_f32 v155, v155, s53, v4
    v_fma_f32 v160, v160, s53, v4
    v_fma_f32 v161, v161, s53, v4
    v_fma_f32 v166, v166, s53, v4
    v_fma_f32 v167, v167, s53, v4
    v_fma_f32 v172, v172, s53, v4
    v_fma_f32 v173, v173, s53, v4
    v_cvt_pk_bf16_f32 v232, v154, v155
    v_cvt_pk_bf16_f32 v233, v160, v161
    v_cvt_pk_bf16_f32 v234, v166, v167
    v_cvt_pk_bf16_f32 v235, v172, v173
    s_nop 1
    v_mfma_f32_16x16x32_bf16 v[160:163], v[232:235], v[246:249], 0
    v_mfma_f32_16x16x32_bf16 v[164:167], v[232:235], v[244:247], 0
    s_nop 6
    v_mul_f32 v152, v240, v160
    v_mul_f32 v153, v240, v164
    v_fmac_f32 v152, v241, v161
    v_fmac_f32 v153, v241, v165
    v_fmac_f32 v152, v242, v162
    v_fmac_f32 v153, v242, v166
    v_fmac_f32 v152, v243, v163
    v_fmac_f32 v153, v243, v167
    v_add_f32 v251, v251, v152
    v_add_f32 v251, v251, v153
    v_mfma_f32_16x16x4_f32 v[168:171], v152, v5, 0
    v_mfma_f32_16x16x4_f32 v[172:175], v153, v5, 0
    s_nop 8
    v_cvt_pk_bf16_f32 v160, 0, v168
    v_cvt_pk_bf16_f32 v161, 0, v169
    v_cvt_pk_bf16_f32 v162, 0, v170
    v_cvt_pk_bf16_f32 v163, 0, v171
    v_cvt_pk_bf16_f32 v164, 0, v172
    v_cvt_pk_bf16_f32 v165, 0, v173
    v_cvt_pk_bf16_f32 v166, 0, v174
    v_cvt_pk_bf16_f32 v167, 0, v175
    v_pk_add_f32 v[160:161], v[168:169], v[160:161] neg_lo:[0,1] neg_hi:[0,1]
    v_pk_add_f32 v[162:163], v[170:171], v[162:163] neg_lo:[0,1] neg_hi:[0,1]
    v_pk_add_f32 v[164:165], v[172:173], v[164:165] neg_lo:[0,1] neg_hi:[0,1]
    v_pk_add_f32 v[166:167], v[174:175], v[166:167] neg_lo:[0,1] neg_hi:[0,1]
    v_cvt_pk_bf16_f32 v228, v160, v168
    v_cvt_pk_bf16_f32 v229, v161, v169
    v_cvt_pk_bf16_f32 v230, v162, v170
    v_cvt_pk_bf16_f32 v231, v163, v171
    v_cvt_pk_bf16_f32 v216, v164, v172
    v_cvt_pk_bf16_f32 v217, v165, v173
    v_cvt_pk_bf16_f32 v218, v166, v174
    v_cvt_pk_bf16_f32 v219, v167, v175
    s_waitcnt vmcnt(8)
    v_lshlrev_b32 v184, 16, v88
    v_lshlrev_b32 v186, 16, v89
    v_lshlrev_b32 v188, 16, v90
    v_lshlrev_b32 v190, 16, v91
    v_and_b32 v185, s48, v88
    v_and_b32 v187, s48, v89
    v_and_b32 v189, s48, v90
    v_and_b32 v191, s48, v91
    v_pk_mul_f32 v[184:185], v[184:185], s[50:51]
    v_pk_mul_f32 v[186:187], v[186:187], s[50:51]
    v_pk_mul_f32 v[188:189], v[188:189], s[50:51]
    v_pk_mul_f32 v[190:191], v[190:191], s[50:51]
    v_cvt_pk_bf16_f32 v88, v184, v185
    v_cvt_pk_bf16_f32 v89, v186, v187
    v_cvt_pk_bf16_f32 v90, v188, v189
    v_cvt_pk_bf16_f32 v91, v190, v191
    v_lshlrev_b32 v184, 16, v92
    v_lshlrev_b32 v186, 16, v93
    v_lshlrev_b32 v188, 16, v94
    v_lshlrev_b32 v190, 16, v95
    v_and_b32 v185, s48, v92
    v_and_b32 v187, s48, v93
    v_and_b32 v189, s48, v94
    v_and_b32 v191, s48, v95
    v_dot2_f32_bf16 v176, v88, v88, 0
    v_dot2_f32_bf16 v176, v89, v89, v176
    v_dot2_f32_bf16 v176, v90, v90, v176
    v_dot2_f32_bf16 v176, v91, v91, v176
    v_mfma_f32_16x16x32_bf16 v[154:157], v[88:91], v[8:11], 0
    v_pk_mul_f32 v[184:185], v[184:185], s[50:51]
    v_pk_mul_f32 v[186:187], v[186:187], s[50:51]
    v_pk_mul_f32 v[188:189], v[188:189], s[50:51]
    v_pk_mul_f32 v[190:191], v[190:191], s[50:51]
    v_cvt_pk_bf16_f32 v92, v184, v185
    v_cvt_pk_bf16_f32 v93, v186, v187
    v_cvt_pk_bf16_f32 v94, v188, v189
    v_cvt_pk_bf16_f32 v95, v190, v191
    v_lshlrev_b32 v184, 16, v96
    v_lshlrev_b32 v186, 16, v97
    v_lshlrev_b32 v188, 16, v98
    v_lshlrev_b32 v190, 16, v99
    v_and_b32 v185, s48, v96
    v_and_b32 v187, s48, v97
    v_and_b32 v189, s48, v98
    v_and_b32 v191, s48, v99
    v_dot2_f32_bf16 v176, v92, v92, v176
    v_dot2_f32_bf16 v176, v93, v93, v176
    v_dot2_f32_bf16 v176, v94, v94, v176
    v_dot2_f32_bf16 v176, v95, v95, v176
    v_mfma_f32_16x16x32_bf16 v[154:157], v[92:95], v[16:19], v[154:157]
    v_pk_mul_f32 v[184:185], v[184:185], s[50:51]
    v_pk_mul_f32 v[186:187], v[186:187], s[50:51]
    v_pk_mul_f32 v[188:189], v[188:189], s[50:51]
    v_pk_mul_f32 v[190:191], v[190:191], s[50:51]
    v_cvt_pk_bf16_f32 v96, v184, v185
    v_cvt_pk_bf16_f32 v97, v186, v187
    v_cvt_pk_bf16_f32 v98, v188, v189
    v_cvt_pk_bf16_f32 v99, v190, v191
    v_lshlrev_b32 v184, 16, v100
    v_lshlrev_b32 v186, 16, v101
    v_lshlrev_b32 v188, 16, v102
    v_lshlrev_b32 v190, 16, v103
    v_and_b32 v185, s48, v100
    v_and_b32 v187, s48, v101
    v_and_b32 v189, s48, v102
    v_and_b32 v191, s48, v103
    v_dot2_f32_bf16 v177, v96, v96, 0
    v_dot2_f32_bf16 v177, v97, v97, v177
    v_dot2_f32_bf16 v177, v98, v98, v177
    v_dot2_f32_bf16 v177, v99, v99, v177
    v_mfma_f32_16x16x32_bf16 v[160:163], v[96:99], v[8:11], 0
    v_mfma_f32_16x16x4_f32 v[194:197], v176, v5, 0
    v_mfma_f32_16x16x32_bf16 v[152:155], v[88:91], v[12:15], v[152:155]
    v_mfma_f32_16x16x32_bf16 v[152:155], v[92:95], v[20:23], v[152:155]
    v_pk_mul_f32 v[184:185], v[184:185], s[50:51]
    v_pk_mul_f32 v[186:187], v[186:187], s[50:51]
    v_pk_mul_f32 v[188:189], v[188:189], s[50:51]
    v_pk_mul_f32 v[190:191], v[190:191], s[50:51]
    v_cvt_pk_bf16_f32 v100, v184, v185
    v_cvt_pk_bf16_f32 v101, v186, v187
    v_cvt_pk_bf16_f32 v102, v188, v189
    v_cvt_pk_bf16_f32 v103, v190, v191
    v_lshlrev_b32 v184, 16, v104
    v_lshlrev_b32 v186, 16, v105
    v_lshlrev_b32 v188, 16, v106
    v_lshlrev_b32 v190, 16, v107
    v_and_b32 v185, s48, v104
    v_and_b32 v187, s48, v105
    v_and_b32 v189, s48, v106
    v_and_b32 v191, s48, v107
    v_dot2_f32_bf16 v177, v100, v100, v177
    v_dot2_f32_bf16 v177, v101, v101, v177
    v_dot2_f32_bf16 v177, v102, v102, v177
    v_dot2_f32_bf16 v177, v103, v103, v177
    v_mfma_f32_16x16x32_bf16 v[160:163], v[100:103], v[16:19], v[160:163]
    v_mfma_f32_16x16x4_f32 v[192:195], v176, v5, v[192:195]
    v_pk_mul_f32 v[184:185], v[184:185], s[50:51]
    v_pk_mul_f32 v[186:187], v[186:187], s[50:51]
    v_pk_mul_f32 v[188:189], v[188:189], s[50:51]
    v_pk_mul_f32 v[190:191], v[190:191], s[50:51]
    v_cvt_pk_bf16_f32 v104, v184, v185
    v_cvt_pk_bf16_f32 v105, v186, v187
    v_cvt_pk_bf16_f32 v106, v188, v189
    v_cvt_pk_bf16_f32 v107, v190, v191
    v_lshlrev_b32 v184, 16, v108
    v_lshlrev_b32 v186, 16, v109
    v_lshlrev_b32 v188, 16, v110
    v_lshlrev_b32 v190, 16, v111
    v_and_b32 v185, s48, v108
    v_and_b32 v187, s48, v109
    v_and_b32 v189, s48, v110
    v_and_b32 v191, s48, v111
    v_dot2_f32_bf16 v178, v104, v104, 0
    v_dot2_f32_bf16 v178, v105, v105, v178
    v_dot2_f32_bf16 v178, v106, v106, v178
    v_dot2_f32_bf16 v178, v107, v107, v178
    v_mfma_f32_16x16x32_bf16 v[166:169], v[104:107], v[8:11], 0
    v_mfma_f32_16x16x4_f32 v[200:203], v177, v5, 0
    v_mfma_f32_16x16x32_bf16 v[158:161], v[96:99], v[12:15], v[158:161]
    v_mfma_f32_16x16x32_bf16 v[158:161], v[100:103], v[20:23], v[158:161]
    v_pk_mul_f32 v[184:185], v[184:185], s[50:51]
    v_pk_mul_f32 v[186:187], v[186:187], s[50:51]
    v_pk_mul_f32 v[188:189], v[188:189], s[50:51]
    v_pk_mul_f32 v[190:191], v[190:191], s[50:51]
    v_cvt_pk_bf16_f32 v108, v184, v185
    v_cvt_pk_bf16_f32 v109, v186, v187
    v_cvt_pk_bf16_f32 v110, v188, v189
    v_cvt_pk_bf16_f32 v111, v190, v191
    v_lshlrev_b32 v184, 16, v112
    v_lshlrev_b32 v186, 16, v113
    v_lshlrev_b32 v188, 16, v114
    v_lshlrev_b32 v190, 16, v115
    v_and_b32 v185, s48, v112
    v_and_b32 v187, s48, v113
    v_and_b32 v189, s48, v114
    v_and_b32 v191, s48, v115
    v_dot2_f32_bf16 v178, v108, v108, v178
    v_dot2_f32_bf16 v178, v109, v109, v178
    v_dot2_f32_bf16 v178, v110, v110, v178
    v_dot2_f32_bf16 v178, v111, v111, v178
    v_mfma_f32_16x16x32_bf16 v[166:169], v[108:111], v[16:19], v[166:169]
    v_mfma_f32_16x16x4_f32 v[198:201], v177, v5, v[198:201]
    v_pk_mul_f32 v[184:185], v[184:185], s[50:51]
    v_pk_mul_f32 v[186:187], v[186:187], s[50:51]
    v_pk_mul_f32 v[188:189], v[188:189], s[50:51]
    v_pk_mul_f32 v[190:191], v[190:191], s[50:51]
    v_cvt_pk_bf16_f32 v112, v184, v185
    v_cvt_pk_bf16_f32 v113, v186, v187
    v_cvt_pk_bf16_f32 v114, v188, v189
    v_cvt_pk_bf16_f32 v115, v190, v191
    v_lshlrev_b32 v184, 16, v116
    v_lshlrev_b32 v186, 16, v117
    v_lshlrev_b32 v188, 16, v118
    v_lshlrev_b32 v190, 16, v119
    v_and_b32 v185, s48, v116
    v_and_b32 v187, s48, v117
    v_and_b32 v189, s48, v118
    v_and_b32 v191, s48, v119
    v_dot2_f32_bf16 v179, v112, v112, 0
    v_dot2_f32_bf16 v179, v113, v113, v179
    v_dot2_f32_bf16 v179, v114, v114, v179
    v_dot2_f32_bf16 v179, v115, v115, v179
    v_mfma_f32_16x16x32_bf16 v[172:175], v[112:115], v[8:11], 0
    v_mfma_f32_16x16x4_f32 v[206:209], v178, v5, 0
    v_mfma_f32_16x16x32_bf16 v[164:167], v[104:107], v[12:15], v[164:167]
    v_mfma_f32_16x16x32_bf16 v[164:167], v[108:111], v[20:23], v[164:167]
    v_pk_mul_f32 v[184:185], v[184:185], s[50:51]
    v_pk_mul_f32 v[186:187], v[186:187], s[50:51]
    v_pk_mul_f32 v[188:189], v[188:189], s[50:51]
    v_pk_mul_f32 v[190:191], v[190:191], s[50:51]
    v_cvt_pk_bf16_f32 v116, v184, v185
    v_cvt_pk_bf16_f32 v117, v186, v187
    v_cvt_pk_bf16_f32 v118, v188, v189
    v_cvt_pk_bf16_f32 v119, v190, v191
    v_dot2_f32_bf16 v179, v116, v116, v179
    v_dot2_f32_bf16 v179, v117, v117, v179
    v_dot2_f32_bf16 v179, v118, v118, v179
    v_dot2_f32_bf16 v179, v119, v119, v179
    v_mfma_f32_16x16x32_bf16 v[172:175], v[116:119], v[16:19], v[172:175]
    v_mfma_f32_16x16x4_f32 v[204:207], v178, v5, v[204:207]
    s_nop 0
    v_mfma_f32_16x16x4_f32 v[212:215], v179, v5, 0
    v_cvt_pk_bf16_f32 v154, 0, v154
    v_cvt_pk_bf16_f32 v155, 0, v155
    v_cvt_pk_bf16_f32 v160, 0, v160
    v_cvt_pk_bf16_f32 v161, 0, v161
    v_cvt_pk_bf16_f32 v194, 0, v194
    v_cvt_pk_bf16_f32 v195, 0, v195
    v_cvt_pk_bf16_f32 v200, 0, v200
    v_cvt_pk_bf16_f32 v201, 0, v201
    v_mfma_f32_16x16x32_bf16 v[170:173], v[112:115], v[12:15], v[170:173]
    v_mfma_f32_16x16x32_bf16 v[170:173], v[116:119], v[20:23], v[170:173]
    v_mfma_f32_16x16x4_f32 v[210:213], v179, v5, v[210:213]
    v_cvt_pk_bf16_f32 v166, 0, v166
    v_cvt_pk_bf16_f32 v167, 0, v167
    v_cvt_pk_bf16_f32 v206, 0, v206
    v_cvt_pk_bf16_f32 v207, 0, v207
    v_fma_f32 v154, v194, -0.5, v154
    v_fma_f32 v155, v195, -0.5, v155
    v_fma_f32 v160, v200, -0.5, v160
    v_fma_f32 v161, v201, -0.5, v161
    v_fma_f32 v166, v206, -0.5, v166
    v_fma_f32 v167, v207, -0.5, v167
    v_cvt_pk_bf16_f32 v154, 0, v154
    v_cvt_pk_bf16_f32 v155, 0, v155
    v_cvt_pk_bf16_f32 v160, 0, v160
    v_cvt_pk_bf16_f32 v161, 0, v161
    v_cvt_pk_bf16_f32 v166, 0, v166
    v_cvt_pk_bf16_f32 v167, 0, v167
    v_cvt_pk_bf16_f32 v172, 0, v172
    v_cvt_pk_bf16_f32 v173, 0, v173
    v_cvt_pk_bf16_f32 v212, 0, v212
    v_cvt_pk_bf16_f32 v213, 0, v213
    v_fma_f32 v172, v212, -0.5, v172
    v_fma_f32 v173, v213, -0.5, v173
    v_cvt_pk_bf16_f32 v172, 0, v172
    v_cvt_pk_bf16_f32 v173, 0, v173
    v_mul_f32 v154, s52, v154
    v_mul_f32 v155, s52, v155
    v_mul_f32 v160, s52, v160
    v_mul_f32 v161, s52, v161
    v_mul_f32 v166, s52, v166
    v_mul_f32 v167, s52, v167
    v_mul_f32 v172, s52, v172
    v_mul_f32 v173, s52, v173
    v_exp_f32 v154, v154
    v_exp_f32 v155, v155
    v_exp_f32 v160, v160
    v_exp_f32 v161, v161
    v_exp_f32 v166, v166
    v_exp_f32 v167, v167
    v_exp_f32 v172, v172
    v_exp_f32 v173, v173
    v_cvt_pk_bf16_f32 v154, 0, v154
    v_cvt_pk_bf16_f32 v155, 0, v155
    v_cvt_pk_bf16_f32 v160, 0, v160
    v_cvt_pk_bf16_f32 v161, 0, v161
    v_cvt_pk_bf16_f32 v166, 0, v166
    v_cvt_pk_bf16_f32 v167, 0, v167
    v_cvt_pk_bf16_f32 v172, 0, v172
    v_cvt_pk_bf16_f32 v173, 0, v173
    v_fma_f32 v154, v154, s53, v4
    v_fma_f32 v155, v155, s53, v4
    v_fma_f32 v160, v160, s53, v4
    v_fma_f32 v161, v161, s53, v4
    v_fma_f32 v166, v166, s53, v4
    v_fma_f32 v167, v167, s53, v4
    v_fma_f32 v172, v172, s53, v4
    v_fma_f32 v173, v173, s53, v4
    v_cvt_pk_bf16_f32 v232, v154, v155
    v_cvt_pk_bf16_f32 v233, v160, v161
    v_cvt_pk_bf16_f32 v234, v166, v167
    v_cvt_pk_bf16_f32 v235, v172, v173
    s_nop 1
    v_mfma_f32_16x16x32_bf16 v[160:163], v[232:235], v[246:249], 0
    v_mfma_f32_16x16x32_bf16 v[164:167], v[232:235], v[244:247], 0
    s_nop 6
    v_mul_f32 v152, v240, v160
    v_mul_f32 v153, v240, v164
    v_fmac_f32 v152, v241, v161
    v_fmac_f32 v153, v241, v165
    v_fmac_f32 v152, v242, v162
    v_fmac_f32 v153, v242, v166
    v_fmac_f32 v152, v243, v163
    v_fmac_f32 v153, v243, v167
    v_add_f32 v251, v251, v152
    v_add_f32 v251, v251, v153
    v_mfma_f32_16x16x4_f32 v[168:171], v152, v5, 0
    v_mfma_f32_16x16x4_f32 v[172:175], v153, v5, 0
    s_nop 8
    v_cvt_pk_bf16_f32 v160, 0, v168
    v_cvt_pk_bf16_f32 v161, 0, v169
    v_cvt_pk_bf16_f32 v162, 0, v170
    v_cvt_pk_bf16_f32 v163, 0, v171
    v_cvt_pk_bf16_f32 v164, 0, v172
    v_cvt_pk_bf16_f32 v165, 0, v173
    v_cvt_pk_bf16_f32 v166, 0, v174
    v_cvt_pk_bf16_f32 v167, 0, v175
    v_pk_add_f32 v[160:161], v[168:169], v[160:161] neg_lo:[0,1] neg_hi:[0,1]
    v_pk_add_f32 v[162:163], v[170:171], v[162:163] neg_lo:[0,1] neg_hi:[0,1]
    v_pk_add_f32 v[164:165], v[172:173], v[164:165] neg_lo:[0,1] neg_hi:[0,1]
    v_pk_add_f32 v[166:167], v[174:175], v[166:167] neg_lo:[0,1] neg_hi:[0,1]
    v_cvt_pk_bf16_f32 v236, v160, v168
    v_cvt_pk_bf16_f32 v237, v161, v169
    v_cvt_pk_bf16_f32 v238, v162, v170
    v_cvt_pk_bf16_f32 v239, v163, v171
    v_cvt_pk_bf16_f32 v252, v164, v172
    v_cvt_pk_bf16_f32 v253, v165, v173
    v_cvt_pk_bf16_f32 v254, v166, v174
    v_cvt_pk_bf16_f32 v255, v167, v175
    s_waitcnt vmcnt(0)
    v_lshlrev_b32 v184, 16, v120
    v_lshlrev_b32 v186, 16, v121
    v_lshlrev_b32 v188, 16, v122
    v_lshlrev_b32 v190, 16, v123
    v_and_b32 v185, s48, v120
    v_and_b32 v187, s48, v121
    v_and_b32 v189, s48, v122
    v_and_b32 v191, s48, v123
    v_pk_mul_f32 v[184:185], v[184:185], s[50:51]
    v_pk_mul_f32 v[186:187], v[186:187], s[50:51]
    v_pk_mul_f32 v[188:189], v[188:189], s[50:51]
    v_pk_mul_f32 v[190:191], v[190:191], s[50:51]
    v_cvt_pk_bf16_f32 v120, v184, v185
    v_cvt_pk_bf16_f32 v121, v186, v187
    v_cvt_pk_bf16_f32 v122, v188, v189
    v_cvt_pk_bf16_f32 v123, v190, v191
    v_lshlrev_b32 v184, 16, v124
    v_lshlrev_b32 v186, 16, v125
    v_lshlrev_b32 v188, 16, v126
    v_lshlrev_b32 v190, 16, v127
    v_and_b32 v185, s48, v124
    v_and_b32 v187, s48, v125
    v_and_b32 v189, s48, v126
    v_and_b32 v191, s48, v127
    v_dot2_f32_bf16 v176, v120, v120, 0
    v_dot2_f32_bf16 v176, v121, v121, v176
    v_dot2_f32_bf16 v176, v122, v122, v176
    v_dot2_f32_bf16 v176, v123, v123, v176
    v_mfma_f32_16x16x32_bf16 v[154:157], v[120:123], v[8:11], 0
    v_pk_mul_f32 v[184:185], v[184:185], s[50:51]
    v_pk_mul_f32 v[186:187], v[186:187], s[50:51]
    v_pk_mul_f32 v[188:189], v[188:189], s[50:51]
    v_pk_mul_f32 v[190:191], v[190:191], s[50:51]
    v_cvt_pk_bf16_f32 v124, v184, v185
    v_cvt_pk_bf16_f32 v125, v186, v187
    v_cvt_pk_bf16_f32 v126, v188, v189
    v_cvt_pk_bf16_f32 v127, v190, v191
    v_lshlrev_b32 v184, 16, v128
    v_lshlrev_b32 v186, 16, v129
    v_lshlrev_b32 v188, 16, v130
    v_lshlrev_b32 v190, 16, v131
    v_and_b32 v185, s48, v128
    v_and_b32 v187, s48, v129
    v_and_b32 v189, s48, v130
    v_and_b32 v191, s48, v131
    v_dot2_f32_bf16 v176, v124, v124, v176
    v_dot2_f32_bf16 v176, v125, v125, v176
    v_dot2_f32_bf16 v176, v126, v126, v176
    v_dot2_f32_bf16 v176, v127, v127, v176
    v_mfma_f32_16x16x32_bf16 v[154:157], v[124:127], v[16:19], v[154:157]
    v_pk_mul_f32 v[184:185], v[184:185], s[50:51]
    v_pk_mul_f32 v[186:187], v[186:187], s[50:51]
    v_pk_mul_f32 v[188:189], v[188:189], s[50:51]
    v_pk_mul_f32 v[190:191], v[190:191], s[50:51]
    v_cvt_pk_bf16_f32 v128, v184, v185
    v_cvt_pk_bf16_f32 v129, v186, v187
    v_cvt_pk_bf16_f32 v130, v188, v189
    v_cvt_pk_bf16_f32 v131, v190, v191
    v_lshlrev_b32 v184, 16, v132
    v_lshlrev_b32 v186, 16, v133
    v_lshlrev_b32 v188, 16, v134
    v_lshlrev_b32 v190, 16, v135
    v_and_b32 v185, s48, v132
    v_and_b32 v187, s48, v133
    v_and_b32 v189, s48, v134
    v_and_b32 v191, s48, v135
    v_dot2_f32_bf16 v177, v128, v128, 0
    v_dot2_f32_bf16 v177, v129, v129, v177
    v_dot2_f32_bf16 v177, v130, v130, v177
    v_dot2_f32_bf16 v177, v131, v131, v177
    v_mfma_f32_16x16x32_bf16 v[160:163], v[128:131], v[8:11], 0
    v_mfma_f32_16x16x4_f32 v[194:197], v176, v5, 0
    v_mfma_f32_16x16x32_bf16 v[152:155], v[120:123], v[12:15], v[152:155]
    v_mfma_f32_16x16x32_bf16 v[152:155], v[124:127], v[20:23], v[152:155]
    v_pk_mul_f32 v[184:185], v[184:185], s[50:51]
    v_pk_mul_f32 v[186:187], v[186:187], s[50:51]
    v_pk_mul_f32 v[188:189], v[188:189], s[50:51]
    v_pk_mul_f32 v[190:191], v[190:191], s[50:51]
    v_cvt_pk_bf16_f32 v132, v184, v185
    v_cvt_pk_bf16_f32 v133, v186, v187
    v_cvt_pk_bf16_f32 v134, v188, v189
    v_cvt_pk_bf16_f32 v135, v190, v191
    v_lshlrev_b32 v184, 16, v136
    v_lshlrev_b32 v186, 16, v137
    v_lshlrev_b32 v188, 16, v138
    v_lshlrev_b32 v190, 16, v139
    v_and_b32 v185, s48, v136
    v_and_b32 v187, s48, v137
    v_and_b32 v189, s48, v138
    v_and_b32 v191, s48, v139
    v_dot2_f32_bf16 v177, v132, v132, v177
    v_dot2_f32_bf16 v177, v133, v133, v177
    v_dot2_f32_bf16 v177, v134, v134, v177
    v_dot2_f32_bf16 v177, v135, v135, v177
    v_mfma_f32_16x16x32_bf16 v[160:163], v[132:135], v[16:19], v[160:163]
    v_mfma_f32_16x16x4_f32 v[192:195], v176, v5, v[192:195]
    v_pk_mul_f32 v[184:185], v[184:185], s[50:51]
    v_pk_mul_f32 v[186:187], v[186:187], s[50:51]
    v_pk_mul_f32 v[188:189], v[188:189], s[50:51]
    v_pk_mul_f32 v[190:191], v[190:191], s[50:51]
    v_cvt_pk_bf16_f32 v136, v184, v185
    v_cvt_pk_bf16_f32 v137, v186, v187
    v_cvt_pk_bf16_f32 v138, v188, v189
    v_cvt_pk_bf16_f32 v139, v190, v191
    v_lshlrev_b32 v184, 16, v140
    v_lshlrev_b32 v186, 16, v141
    v_lshlrev_b32 v188, 16, v142
    v_lshlrev_b32 v190, 16, v143
    v_and_b32 v185, s48, v140
    v_and_b32 v187, s48, v141
    v_and_b32 v189, s48, v142
    v_and_b32 v191, s48, v143
    v_dot2_f32_bf16 v178, v136, v136, 0
    v_dot2_f32_bf16 v178, v137, v137, v178
    v_dot2_f32_bf16 v178, v138, v138, v178
    v_dot2_f32_bf16 v178, v139, v139, v178
    v_mfma_f32_16x16x32_bf16 v[166:169], v[136:139], v[8:11], 0
    v_mfma_f32_16x16x4_f32 v[200:203], v177, v5, 0
    v_mfma_f32_16x16x32_bf16 v[158:161], v[128:131], v[12:15], v[158:161]
    v_mfma_f32_16x16x32_bf16 v[158:161], v[132:135], v[20:23], v[158:161]
    v_pk_mul_f32 v[184:185], v[184:185], s[50:51]
    v_pk_mul_f32 v[186:187], v[186:187], s[50:51]
    v_pk_mul_f32 v[188:189], v[188:189], s[50:51]
    v_pk_mul_f32 v[190:191], v[190:191], s[50:51]
    v_cvt_pk_bf16_f32 v140, v184, v185
    v_cvt_pk_bf16_f32 v141, v186, v187
    v_cvt_pk_bf16_f32 v142, v188, v189
    v_cvt_pk_bf16_f32 v143, v190, v191
    v_lshlrev_b32 v184, 16, v144
    v_lshlrev_b32 v186, 16, v145
    v_lshlrev_b32 v188, 16, v146
    v_lshlrev_b32 v190, 16, v147
    v_and_b32 v185, s48, v144
    v_and_b32 v187, s48, v145
    v_and_b32 v189, s48, v146
    v_and_b32 v191, s48, v147
    v_dot2_f32_bf16 v178, v140, v140, v178
    v_dot2_f32_bf16 v178, v141, v141, v178
    v_dot2_f32_bf16 v178, v142, v142, v178
    v_dot2_f32_bf16 v178, v143, v143, v178
    v_mfma_f32_16x16x32_bf16 v[166:169], v[140:143], v[16:19], v[166:169]
    v_mfma_f32_16x16x4_f32 v[198:201], v177, v5, v[198:201]
    v_pk_mul_f32 v[184:185], v[184:185], s[50:51]
    v_pk_mul_f32 v[186:187], v[186:187], s[50:51]
    v_pk_mul_f32 v[188:189], v[188:189], s[50:51]
    v_pk_mul_f32 v[190:191], v[190:191], s[50:51]
    v_cvt_pk_bf16_f32 v144, v184, v185
    v_cvt_pk_bf16_f32 v145, v186, v187
    v_cvt_pk_bf16_f32 v146, v188, v189
    v_cvt_pk_bf16_f32 v147, v190, v191
    v_lshlrev_b32 v184, 16, v148
    v_lshlrev_b32 v186, 16, v149
    v_lshlrev_b32 v188, 16, v150
    v_lshlrev_b32 v190, 16, v151
    v_and_b32 v185, s48, v148
    v_and_b32 v187, s48, v149
    v_and_b32 v189, s48, v150
    v_and_b32 v191, s48, v151
    v_dot2_f32_bf16 v179, v144, v144, 0
    v_dot2_f32_bf16 v179, v145, v145, v179
    v_dot2_f32_bf16 v179, v146, v146, v179
    v_dot2_f32_bf16 v179, v147, v147, v179
    v_mfma_f32_16x16x32_bf16 v[172:175], v[144:147], v[8:11], 0
    v_mfma_f32_16x16x4_f32 v[206:209], v178, v5, 0
    v_mfma_f32_16x16x32_bf16 v[164:167], v[136:139], v[12:15], v[164:167]
    v_mfma_f32_16x16x32_bf16 v[164:167], v[140:143], v[20:23], v[164:167]
    v_pk_mul_f32 v[184:185], v[184:185], s[50:51]
    v_pk_mul_f32 v[186:187], v[186:187], s[50:51]
    v_pk_mul_f32 v[188:189], v[188:189], s[50:51]
    v_pk_mul_f32 v[190:191], v[190:191], s[50:51]
    v_cvt_pk_bf16_f32 v148, v184, v185
    v_cvt_pk_bf16_f32 v149, v186, v187
    v_cvt_pk_bf16_f32 v150, v188, v189
    v_cvt_pk_bf16_f32 v151, v190, v191
    v_dot2_f32_bf16 v179, v148, v148, v179
    v_dot2_f32_bf16 v179, v149, v149, v179
    v_dot2_f32_bf16 v179, v150, v150, v179
    v_dot2_f32_bf16 v179, v151, v151, v179
    v_mfma_f32_16x16x32_bf16 v[172:175], v[148:151], v[16:19], v[172:175]
    v_mfma_f32_16x16x4_f32 v[204:207], v178, v5, v[204:207]
    s_nop 0
    v_mfma_f32_16x16x4_f32 v[212:215], v179, v5, 0
    v_cvt_pk_bf16_f32 v154, 0, v154
    v_cvt_pk_bf16_f32 v155, 0, v155
    v_cvt_pk_bf16_f32 v160, 0, v160
    v_cvt_pk_bf16_f32 v161, 0, v161
    v_cvt_pk_bf16_f32 v194, 0, v194
    v_cvt_pk_bf16_f32 v195, 0, v195
    v_cvt_pk_bf16_f32 v200, 0, v200
    v_cvt_pk_bf16_f32 v201, 0, v201
    v_mfma_f32_16x16x32_bf16 v[170:173], v[144:147], v[12:15], v[170:173]
    v_mfma_f32_16x16x32_bf16 v[170:173], v[148:151], v[20:23], v[170:173]
    v_mfma_f32_16x16x4_f32 v[210:213], v179, v5, v[210:213]
    s_cmp_eq_u32 s18, 7
    s_cbranch_scc1 L_vlater
    buffer_load_dwordx4 v[24:27], v2, s[24:27], 0 offen offset:0 nt
    buffer_load_dwordx4 v[28:31], v2, s[24:27], 0 offen offset:1024 nt
    buffer_load_dwordx4 v[32:35], v2, s[24:27], s41 offen offset:0 nt
    buffer_load_dwordx4 v[36:39], v2, s[24:27], s41 offen offset:1024 nt
    buffer_load_dwordx4 v[40:43], v2, s[24:27], s42 offen offset:0 nt
    buffer_load_dwordx4 v[44:47], v2, s[24:27], s42 offen offset:1024 nt
    buffer_load_dwordx4 v[48:51], v2, s[24:27], s43 offen offset:0 nt
    buffer_load_dwordx4 v[52:55], v2, s[24:27], s43 offen offset:1024 nt
    buffer_load_dwordx4 v[56:59], v2, s[24:27], 0 offen offset:2048 nt
    buffer_load_dwordx4 v[60:63], v2, s[24:27], 0 offen offset:3072 nt
    buffer_load_dwordx4 v[64:67], v2, s[24:27], s41 offen offset:2048 nt
    buffer_load_dwordx4 v[68:71], v2, s[24:27], s41 offen offset:3072 nt
    buffer_load_dwordx4 v[72:75], v2, s[24:27], s42 offen offset:2048 nt
    buffer_load_dwordx4 v[76:79], v2, s[24:27], s42 offen offset:3072 nt
    buffer_load_dwordx4 v[80:83], v2, s[24:27], s43 offen offset:2048 nt
    buffer_load_dwordx4 v[84:87], v2, s[24:27], s43 offen offset:3072 nt
    buffer_load_dwordx4 v[88:91], v2, s[24:27], s44 offen offset:0 nt
    buffer_load_dwordx4 v[92:95], v2, s[24:27], s44 offen offset:1024 nt
    buffer_load_dwordx4 v[96:99], v2, s[24:27], s45 offen offset:0 nt
    buffer_load_dwordx4 v[100:103], v2, s[24:27], s45 offen offset:1024 nt
    buffer_load_dwordx4 v[104:107], v2, s[24:27], s46 offen offset:0 nt
    buffer_load_dwordx4 v[108:111], v2, s[24:27], s46 offen offset:1024 nt
    buffer_load_dwordx4 v[112:115], v2, s[24:27], s47 offen offset:0 nt
    buffer_load_dwordx4 v[116:119], v2, s[24:27], s47 offen offset:1024 nt
    buffer_load_dwordx4 v[120:123], v2, s[24:27], s44 offen offset:2048 nt
    buffer_load_dwordx4 v[124:127], v2, s[24:27], s44 offen offset:3072 nt
    buffer_load_dwordx4 v[128:131], v2, s[24:27], s45 offen offset:2048 nt
    buffer_load_dwordx4 v[132:135], v2, s[24:27], s45 offen offset:3072 nt
    buffer_load_dwordx4 v[136:139], v2, s[24:27], s46 offen offset:2048 nt
    buffer_load_dwordx4 v[140:143], v2, s[24:27], s46 offen offset:3072 nt
    buffer_load_dwordx4 v[144:147], v2, s[24:27], s47 offen offset:2048 nt
    buffer_load_dwordx4 v[148:151], v2, s[24:27], s47 offen offset:3072 nt
    s_cmp_lt_u32 s18, 4
    s_cbranch_scc1 L_vlater
    s_barrier
L_vlater:
    v_cvt_pk_bf16_f32 v166, 0, v166
    v_cvt_pk_bf16_f32 v167, 0, v167
    v_cvt_pk_bf16_f32 v206, 0, v206
    v_cvt_pk_bf16_f32 v207, 0, v207
    v_fma_f32 v154, v194, -0.5, v154
    v_fma_f32 v155, v195, -0.5, v155
    v_fma_f32 v160, v200, -0.5, v160
    v_fma_f32 v161, v201, -0.5, v161
    v_fma_f32 v166, v206, -0.5, v166
    v_fma_f32 v167, v207, -0.5, v167
    v_cvt_pk_bf16_f32 v154, 0, v154
    v_cvt_pk_bf16_f32 v155, 0, v155
    v_cvt_pk_bf16_f32 v160, 0, v160
    v_cvt_pk_bf16_f32 v161, 0, v161
    v_cvt_pk_bf16_f32 v166, 0, v166
    v_cvt_pk_bf16_f32 v167, 0, v167
    v_cvt_pk_bf16_f32 v172, 0, v172
    v_cvt_pk_bf16_f32 v173, 0, v173
    v_cvt_pk_bf16_f32 v212, 0, v212
    v_cvt_pk_bf16_f32 v213, 0, v213
    v_fma_f32 v172, v212, -0.5, v172
    v_fma_f32 v173, v213, -0.5, v173
    v_cvt_pk_bf16_f32 v172, 0, v172
    v_cvt_pk_bf16_f32 v173, 0, v173
    v_mul_f32 v154, s52, v154
    v_mul_f32 v155, s52, v155
    v_mul_f32 v160, s52, v160
    v_mul_f32 v161, s52, v161
    v_mul_f32 v166, s52, v166
    v_mul_f32 v167, s52, v167
    v_mul_f32 v172, s52, v172
    v_mul_f32 v173, s52, v173
    v_exp_f32 v154, v154
    v_exp_f32 v155, v155
    v_exp_f32 v160, v160
    v_exp_f32 v161, v161
    v_exp_f32 v166, v166
    v_exp_f32 v167, v167
    v_exp_f32 v172, v172
    v_exp_f32 v173, v173
    v_cvt_pk_bf16_f32 v154, 0, v154
    v_cvt_pk_bf16_f32 v155, 0, v155
    v_cvt_pk_bf16_f32 v160, 0, v160
    v_cvt_pk_bf16_f32 v161, 0, v161
    v_cvt_pk_bf16_f32 v166, 0, v166
    v_cvt_pk_bf16_f32 v167, 0, v167
    v_cvt_pk_bf16_f32 v172, 0, v172
    v_cvt_pk_bf16_f32 v173, 0, v173
    v_fma_f32 v154, v154, s53, v4
    v_fma_f32 v155, v155, s53, v4
    v_fma_f32 v160, v160, s53, v4
    v_fma_f32 v161, v161, s53, v4
    v_fma_f32 v166, v166, s53, v4
    v_fma_f32 v167, v167, s53, v4
    v_fma_f32 v172, v172, s53, v4
    v_fma_f32 v173, v173, s53, v4
    v_cvt_pk_bf16_f32 v232, v154, v155
    v_cvt_pk_bf16_f32 v233, v160, v161
    v_cvt_pk_bf16_f32 v234, v166, v167
    v_cvt_pk_bf16_f32 v235, v172, v173
    s_nop 1
    v_mfma_f32_16x16x32_bf16 v[160:163], v[232:235], v[246:249], 0
    v_mfma_f32_16x16x32_bf16 v[164:167], v[232:235], v[244:247], 0
    v_and_b32 v152, 4, v0
    v_cmp_eq_u32 vcc, 0, v152
    s_nop 1
    v_cndmask_b32 v244, 0, 1.0, vcc
    v_cndmask_b32 v245, 1.0, 0, vcc
    v_pk_mul_f32 v[184:185], v[220:221], v[244:245] op_sel:[0,0] op_sel_hi:[0,1]
    v_pk_mul_f32 v[186:187], v[220:221], v[244:245] op_sel:[1,0] op_sel_hi:[1,1]
    v_pk_mul_f32 v[188:189], v[222:223], v[244:245] op_sel:[0,0] op_sel_hi:[0,1]
    v_pk_mul_f32 v[190:191], v[222:223], v[244:245] op_sel:[1,0] op_sel_hi:[1,1]
    v_mul_f32 v152, v240, v160
    v_mul_f32 v153, v240, v164
    v_fmac_f32 v152, v241, v161
    v_fmac_f32 v153, v241, v165
    v_fmac_f32 v152, v242, v162
    v_fmac_f32 v153, v242, v166
    v_fmac_f32 v152, v243, v163
    v_fmac_f32 v153, v243, v167
    v_add_f32 v251, v251, v152
    v_add_f32 v251, v251, v153
    v_mfma_f32_16x16x4_f32 v[168:171], v152, v5, 0
    v_mfma_f32_16x16x4_f32 v[172:175], v153, v5, 0
    v_pk_mul_f32 v[192:193], v[224:225], v[244:245] op_sel:[0,0] op_sel_hi:[0,1]
    v_pk_mul_f32 v[194:195], v[224:225], v[244:245] op_sel:[1,0] op_sel_hi:[1,1]
    v_pk_mul_f32 v[196:197], v[226:227], v[244:245] op_sel:[0,0] op_sel_hi:[0,1]
    v_pk_mul_f32 v[198:199], v[226:227], v[244:245] op_sel:[1,0] op_sel_hi:[1,1]
    v_pk_mul_f32 v[200:201], v[228:229], v[244:245] op_sel:[0,0] op_sel_hi:[0,1]
    v_pk_mul_f32 v[202:203], v[228:229], v[244:245] op_sel:[1,0] op_sel_hi:[1,1]
    v_pk_mul_f32 v[204:205], v[230:231], v[244:245] op_sel:[0,0] op_sel_hi:[0,1]
    v_pk_mul_f32 v[206:207], v[230:231], v[244:245] op_sel:[1,0] op_sel_hi:[1,1]
    v_pk_mul_f32 v[208:209], v[216:217], v[244:245] op_sel:[0,0] op_sel_hi:[0,1]
    v_pk_mul_f32 v[210:211], v[216:217], v[244:245] op_sel:[1,0] op_sel_hi:[1,1]
    v_pk_mul_f32 v[212:213], v[218:219], v[244:245] op_sel:[0,0] op_sel_hi:[0,1]
    v_pk_mul_f32 v[214:215], v[218:219], v[244:245] op_sel:[1,0] op_sel_hi:[1,1]
    v_mfma_f32_16x16x4_f32 v[216:219], v251, v5, 0
    v_cvt_pk_bf16_f32 v160, 0, v168
    v_cvt_pk_bf16_f32 v161, 0, v169
    v_cvt_pk_bf16_f32 v162, 0, v170
    v_cvt_pk_bf16_f32 v163, 0, v171
    v_cvt_pk_bf16_f32 v164, 0, v172
    v_cvt_pk_bf16_f32 v165, 0, v173
    v_cvt_pk_bf16_f32 v166, 0, v174
    v_cvt_pk_bf16_f32 v167, 0, v175
    v_pk_add_f32 v[160:161], v[168:169], v[160:161] neg_lo:[0,1] neg_hi:[0,1]
    v_pk_add_f32 v[162:163], v[170:171], v[162:163] neg_lo:[0,1] neg_hi:[0,1]
    v_pk_add_f32 v[164:165], v[172:173], v[164:165] neg_lo:[0,1] neg_hi:[0,1]
    v_pk_add_f32 v[166:167], v[174:175], v[166:167] neg_lo:[0,1] neg_hi:[0,1]
    v_cvt_pk_bf16_f32 v176, v160, v168
    v_cvt_pk_bf16_f32 v177, v161, v169
    v_cvt_pk_bf16_f32 v178, v162, v170
    v_cvt_pk_bf16_f32 v179, v163, v171
    v_cvt_pk_bf16_f32 v180, v164, v172
    v_cvt_pk_bf16_f32 v181, v165, v173
    v_cvt_pk_bf16_f32 v182, v166, v174
    v_cvt_pk_bf16_f32 v183, v167, v175
    v_pk_add_f32 v[216:217], v[216:217], v[218:219]
    v_mov_b32 v232, 0
    v_mov_b32 v233, 0
    v_mov_b32 v234, 0
    v_mov_b32 v235, 0
    v_add_f32 v251, v216, v217
    v_pk_mul_f32 v[8:9], v[236:237], v[244:245] op_sel:[0,0] op_sel_hi:[0,1]
    v_pk_mul_f32 v[10:11], v[236:237], v[244:245] op_sel:[1,0] op_sel_hi:[1,1]
    v_mfma_f32_16x16x4_f32 v[216:219], v251, v5, 0
    v_pk_mul_f32 v[12:13], v[238:239], v[244:245] op_sel:[0,0] op_sel_hi:[0,1]
    v_pk_mul_f32 v[14:15], v[238:239], v[244:245] op_sel:[1,0] op_sel_hi:[1,1]
    v_pk_mul_f32 v[16:17], v[252:253], v[244:245] op_sel:[0,0] op_sel_hi:[0,1]
    v_pk_mul_f32 v[18:19], v[252:253], v[244:245] op_sel:[1,0] op_sel_hi:[1,1]
    v_pk_mul_f32 v[20:21], v[254:255], v[244:245] op_sel:[0,0] op_sel_hi:[0,1]
    v_pk_mul_f32 v[22:23], v[254:255], v[244:245] op_sel:[1,0] op_sel_hi:[1,1]
    v_pk_mul_f32 v[152:153], v[176:177], v[244:245] op_sel:[0,0] op_sel_hi:[0,1]
    v_pk_mul_f32 v[154:155], v[176:177], v[244:245] op_sel:[1,0] op_sel_hi:[1,1]
    v_pk_mul_f32 v[156:157], v[178:179], v[244:245] op_sel:[0,0] op_sel_hi:[0,1]
    v_pk_mul_f32 v[158:159], v[178:179], v[244:245] op_sel:[1,0] op_sel_hi:[1,1]
    v_pk_mul_f32 v[160:161], v[180:181], v[244:245] op_sel:[0,0] op_sel_hi:[0,1]
    v_pk_mul_f32 v[162:163], v[180:181], v[244:245] op_sel:[1,0] op_sel_hi:[1,1]
    v_pk_mul_f32 v[164:165], v[182:183], v[244:245] op_sel:[0,0] op_sel_hi:[0,1]
    v_pk_mul_f32 v[166:167], v[182:183], v[244:245] op_sel:[1,0] op_sel_hi:[1,1]
    s_waitcnt lgkmcnt(0)
    s_add_u32 s62, s62, 0x9e3779b9
    s_cmp_eq_u32 s18, 7
    s_mov_b64 exec, 1
    ds_write_b32 v250, v216
    s_mov_b64 exec, -1
    s_cbranch_scc1 L_last
    s_waitcnt vmcnt(30)
    v_smfmac_f32_16x16x64_bf16 v[232:235], v[184:187], v[24:31], v1
    s_waitcnt vmcnt(28)
    v_smfmac_f32_16x16x64_bf16 v[232:235], v[188:191], v[32:39], v1
    s_waitcnt vmcnt(26)
    v_smfmac_f32_16x16x64_bf16 v[232:235], v[192:195], v[40:47], v1
    s_waitcnt vmcnt(24)
    v_smfmac_f32_16x16x64_bf16 v[232:235], v[196:199], v[48:55], v1
    s_waitcnt vmcnt(22)
    v_smfmac_f32_16x16x64_bf16 v[232:235], v[200:203], v[56:63], v1
    s_waitcnt vmcnt(20)
    v_smfmac_f32_16x16x64_bf16 v[232:235], v[204:207], v[64:71], v1
    s_waitcnt vmcnt(18)
    v_smfmac_f32_16x16x64_bf16 v[232:235], v[208:211], v[72:79], v1
    s_waitcnt vmcnt(16)
    v_smfmac_f32_16x16x64_bf16 v[232:235], v[212:215], v[80:87], v1
    s_waitcnt vmcnt(14)
    v_smfmac_f32_16x16x64_bf16 v[232:235], v[8:11], v[88:95], v1
    s_waitcnt vmcnt(12)
    v_smfmac_f32_16x16x64_bf16 v[232:235], v[12:15], v[96:103], v1
    s_waitcnt vmcnt(10)
    v_smfmac_f32_16x16x64_bf16 v[232:235], v[16:19], v[104:111], v1
    s_waitcnt vmcnt(8)
    v_smfmac_f32_16x16x64_bf16 v[232:235], v[20:23], v[112:119], v1
    s_waitcnt vmcnt(6)
    v_smfmac_f32_16x16x64_bf16 v[232:235], v[152:155], v[120:127], v1
    s_waitcnt vmcnt(4)
    v_smfmac_f32_16x16x64_bf16 v[232:235], v[156:159], v[128:135], v1
    s_waitcnt vmcnt(2)
    v_smfmac_f32_16x16x64_bf16 v[232:235], v[160:163], v[136:143], v1
    s_waitcnt vmcnt(0)
    v_smfmac_f32_16x16x64_bf16 v[232:235], v[164:167], v[144:151], v1
    s_nop 7
    ds_write_b64 v6, v[232:233]
    s_waitcnt lgkmcnt(0)
    s_endpgm
L_last:
    v_mov_b32 v246, 0
    v_mov_b32 v231, s62
    s_add_u32 s38, s57, 8192
    v_and_b32 v6, 15, v0
    v_bfe_u32 v168, v0, 4, 1
    v_lshl_add_u32 v6, v6, 1, v168
    v_lshrrev_b32 v168, 5, v0
    v_lshl_add_u32 v6, v6, 1, v168
    v_lshlrev_b32 v6, 2, v6
    v_mul_f32 v4, s53, v4
    s_waitcnt lgkmcnt(0)
    s_barrier
    buffer_load_dwordx4 v[24:27], v2, s[24:27], 0 offen offset:0 nt
    buffer_load_dwordx4 v[28:31], v2, s[24:27], 0 offen offset:1024 nt
    buffer_load_dwordx4 v[32:35], v2, s[24:27], s41 offen offset:0 nt
    buffer_load_dwordx4 v[36:39], v2, s[24:27], s41 offen offset:1024 nt
    buffer_load_dwordx4 v[40:43], v2, s[24:27], s42 offen offset:0 nt
    buffer_load_dwordx4 v[44:47], v2, s[24:27], s42 offen offset:1024 nt
    buffer_load_dwordx4 v[48:51], v2, s[24:27], s43 offen offset:0 nt
    buffer_load_dwordx4 v[52:55], v2, s[24:27], s43 offen offset:1024 nt
    buffer_load_dwordx4 v[56:59], v2, s[24:27], 0 offen offset:2048 nt
    buffer_load_dwordx4 v[60:63], v2, s[24:27], 0 offen offset:3072 nt
    buffer_load_dwordx4 v[64:67], v2, s[24:27], s41 offen offset:2048 nt
    buffer_load_dwordx4 v[68:71], v2, s[24:27], s41 offen offset:3072 nt
    buffer_load_dwordx4 v[72:75], v2, s[24:27], s42 offen offset:2048 nt
    buffer_load_dwordx4 v[76:79], v2, s[24:27], s42 offen offset:3072 nt
    buffer_load_dwordx4 v[80:83], v2, s[24:27], s43 offen offset:2048 nt
    buffer_load_dwordx4 v[84:87], v2, s[24:27], s43 offen offset:3072 nt
    buffer_load_dwordx4 v[88:91], v2, s[24:27], s44 offen offset:0 nt
    buffer_load_dwordx4 v[92:95], v2, s[24:27], s44 offen offset:1024 nt
    buffer_load_dwordx4 v[96:99], v2, s[24:27], s45 offen offset:0 nt
    buffer_load_dwordx4 v[100:103], v2, s[24:27], s45 offen offset:1024 nt
    buffer_load_dwordx4 v[104:107], v2, s[24:27], s46 offen offset:0 nt
    buffer_load_dwordx4 v[108:111], v2, s[24:27], s46 offen offset:1024 nt
    buffer_load_dwordx4 v[112:115], v2, s[24:27], s47 offen offset:0 nt
    buffer_load_dwordx4 v[116:119], v2, s[24:27], s47 offen offset:1024 nt
    buffer_load_dwordx4 v[120:123], v2, s[24:27], s44 offen offset:2048 nt
    buffer_load_dwordx4 v[124:127], v2, s[24:27], s44 offen offset:3072 nt
    buffer_load_dwordx4 v[128:131], v2, s[24:27], s45 offen offset:2048 nt
    buffer_load_dwordx4 v[132:135], v2, s[24:27], s45 offen offset:3072 nt
    buffer_load_dwordx4 v[136:139], v2, s[24:27], s46 offen offset:2048 nt
    buffer_load_dwordx4 v[140:143], v2, s[24:27], s46 offen offset:3072 nt
    buffer_load_dwordx4 v[144:147], v2, s[24:27], s47 offen offset:2048 nt
    buffer_load_dwordx4 v[148:151], v2, s[24:27], s47 offen offset:3072 nt
    s_barrier
    ds_read_b64 v[168:169], v7 offset:0
    ds_read_b64 v[170:171], v7 offset:512
    ds_read_b64 v[172:173], v7 offset:1024
    ds_read_b64 v[174:175], v7 offset:1536
    ds_read_b64 v[176:177], v7 offset:2048
    ds_read_b64 v[178:179], v7 offset:2560
    ds_read_b64 v[180:181], v7 offset:3072
    ds_read_b128 v[220:223], v246 offset:4096
    ds_read_b128 v[224:227], v246 offset:4112
    s_waitcnt lgkmcnt(2)
    v_pk_add_f32 v[168:169], v[168:169], v[170:171]
    v_pk_add_f32 v[172:173], v[172:173], v[174:175]
    v_pk_add_f32 v[176:177], v[176:177], v[178:179]
    v_pk_add_f32 v[168:169], v[168:169], v[172:173]
    v_pk_add_f32 v[176:177], v[176:177], v[180:181]
    s_waitcnt lgkmcnt(0)
    v_pk_add_f32 v[232:233], v[168:169], v[176:177]
    v_pk_add_f32 v[220:221], v[220:221], v[222:223]
    v_pk_add_f32 v[224:225], v[224:225], v[226:227]
    v_pk_add_f32 v[220:221], v[220:221], v[224:225]
    v_add_f32 v230, v220, v221
    s_waitcnt vmcnt(30)
    v_smfmac_f32_16x16x64_bf16 v[232:235], v[184:187], v[24:31], v1
    s_waitcnt vmcnt(28)
    v_smfmac_f32_16x16x64_bf16 v[232:235], v[188:191], v[32:39], v1
    s_waitcnt vmcnt(26)
    v_smfmac_f32_16x16x64_bf16 v[232:235], v[192:195], v[40:47], v1
    s_waitcnt vmcnt(24)
    v_smfmac_f32_16x16x64_bf16 v[232:235], v[196:199], v[48:55], v1
    s_waitcnt vmcnt(22)
    v_smfmac_f32_16x16x64_bf16 v[232:235], v[200:203], v[56:63], v1
    s_waitcnt vmcnt(20)
    v_smfmac_f32_16x16x64_bf16 v[232:235], v[204:207], v[64:71], v1
    s_waitcnt vmcnt(18)
    v_smfmac_f32_16x16x64_bf16 v[232:235], v[208:211], v[72:79], v1
    s_waitcnt vmcnt(16)
    v_smfmac_f32_16x16x64_bf16 v[232:235], v[212:215], v[80:87], v1
    s_waitcnt vmcnt(14)
    v_smfmac_f32_16x16x64_bf16 v[232:235], v[8:11], v[88:95], v1
    s_waitcnt vmcnt(12)
    v_smfmac_f32_16x16x64_bf16 v[232:235], v[12:15], v[96:103], v1
    s_waitcnt vmcnt(10)
    v_smfmac_f32_16x16x64_bf16 v[232:235], v[16:19], v[104:111], v1
    s_waitcnt vmcnt(8)
    v_smfmac_f32_16x16x64_bf16 v[232:235], v[20:23], v[112:119], v1
    s_waitcnt vmcnt(6)
    v_smfmac_f32_16x16x64_bf16 v[232:235], v[152:155], v[120:127], v1
    s_waitcnt vmcnt(4)
    v_smfmac_f32_16x16x64_bf16 v[232:235], v[156:159], v[128:135], v1
    s_waitcnt vmcnt(2)
    v_smfmac_f32_16x16x64_bf16 v[232:235], v[160:163], v[136:143], v1
    s_waitcnt vmcnt(0)
    v_smfmac_f32_16x16x64_bf16 v[232:235], v[164:167], v[144:151], v1
    s_cmp_eq_u32 s3, 0
    s_cbranch_scc1 L_cons
    s_nop 5
    buffer_store_dwordx4 v[230:233], v2, s[28:31], s38 offen
    buffer_store_dwordx4 v[230:233], v2, s[28:31], s57 offen sc1
    s_endpgm
L_cons:
    s_movk_i32 s40, 0x2000
    s_movk_i32 s41, 0x3000
    s_mov_b32 s38, 0x40000
    buffer_load_dwordx4 v[72:75], v2, s[28:31], s40 offen offset:1024 sc1
    buffer_load_dwordx4 v[76:79], v2, s[28:31], s40 offen offset:2048 sc1
    buffer_load_dwordx4 v[80:83], v2, s[28:31], s40 offen offset:3072 sc1
    buffer_load_dwordx4 v[84:87], v2, s[28:31], s41 offen offset:0 sc1
    buffer_load_dwordx4 v[88:91], v2, s[28:31], s41 offen offset:1024 sc1
    buffer_load_dwordx4 v[92:95], v2, s[28:31], s41 offen offset:2048 sc1
    buffer_load_dwordx4 v[96:99], v2, s[28:31], s41 offen offset:3072 sc1
L_poll:
    buffer_load_dwordx4 v[100:103], v2, s[28:31], s40 offen offset:1024 sc1
    buffer_load_dwordx4 v[104:107], v2, s[28:31], s40 offen offset:2048 sc1
    buffer_load_dwordx4 v[108:111], v2, s[28:31], s40 offen offset:3072 sc1
    buffer_load_dwordx4 v[112:115], v2, s[28:31], s41 offen offset:0 sc1
    buffer_load_dwordx4 v[116:119], v2, s[28:31], s41 offen offset:1024 sc1
    buffer_load_dwordx4 v[120:123], v2, s[28:31], s41 offen offset:2048 sc1
    buffer_load_dwordx4 v[124:127], v2, s[28:31], s41 offen offset:3072 sc1
    s_cmp_eq_u32 s38, 0x3ffd0
    s_cselect_b32 s40, 0, s40
    s_cselect_b32 s41, 0x1000, s41
    s_waitcnt vmcnt(13)
    v_xor_b32 v60, s62, v73
    s_waitcnt vmcnt(12)
    v_bitop3_b32 v60, v77, s62, v60 bitop3:0xbe
    s_waitcnt vmcnt(11)
    v_bitop3_b32 v60, v81, s62, v60 bitop3:0xbe
    s_waitcnt vmcnt(10)
    v_bitop3_b32 v60, v85, s62, v60 bitop3:0xbe
    s_waitcnt vmcnt(9)
    v_bitop3_b32 v60, v89, s62, v60 bitop3:0xbe
    s_waitcnt vmcnt(8)
    v_bitop3_b32 v60, v93, s62, v60 bitop3:0xbe
    s_waitcnt vmcnt(7)
    v_bitop3_b32 v60, v97, s62, v60 bitop3:0xbe
    v_cmp_ne_u32 vcc, 0, v60
    s_cbranch_vccz L_rdy0
    buffer_load_dwordx4 v[72:75], v2, s[28:31], s40 offen offset:1024 sc1
    buffer_load_dwordx4 v[76:79], v2, s[28:31], s40 offen offset:2048 sc1
    buffer_load_dwordx4 v[80:83], v2, s[28:31], s40 offen offset:3072 sc1
    buffer_load_dwordx4 v[84:87], v2, s[28:31], s41 offen offset:0 sc1
    buffer_load_dwordx4 v[88:91], v2, s[28:31], s41 offen offset:1024 sc1
    buffer_load_dwordx4 v[92:95], v2, s[28:31], s41 offen offset:2048 sc1
    buffer_load_dwordx4 v[96:99], v2, s[28:31], s41 offen offset:3072 sc1
    s_waitcnt vmcnt(13)
    v_xor_b32 v60, s62, v101
    s_waitcnt vmcnt(12)
    v_bitop3_b32 v60, v105, s62, v60 bitop3:0xbe
    s_waitcnt vmcnt(11)
    v_bitop3_b32 v60, v109, s62, v60 bitop3:0xbe
    s_waitcnt vmcnt(10)
    v_bitop3_b32 v60, v113, s62, v60 bitop3:0xbe
    s_waitcnt vmcnt(9)
    v_bitop3_b32 v60, v117, s62, v60 bitop3:0xbe
    s_waitcnt vmcnt(8)
    v_bitop3_b32 v60, v121, s62, v60 bitop3:0xbe
    s_waitcnt vmcnt(7)
    v_bitop3_b32 v60, v125, s62, v60 bitop3:0xbe
    v_cmp_ne_u32 vcc, 0, v60
    s_cbranch_vccz L_rdy1
    s_sub_u32 s38, s38, 1
    s_cbranch_scc0 L_poll
L_rdy1:
    v_add_f32 v230, v230, v100
    v_add_f32 v104, v104, v108
    v_add_f32 v112, v112, v116
    v_add_f32 v120, v120, v124
    v_add_f32 v104, v104, v112
    v_pk_add_f32 v[232:233], v[232:233], v[102:103]
    v_add_f32 v230, v230, v120
    v_pk_add_f32 v[106:107], v[106:107], v[110:111]
    v_pk_add_f32 v[114:115], v[114:115], v[118:119]
    v_pk_add_f32 v[122:123], v[122:123], v[126:127]
    v_add_f32 v230, v230, v104
    v_pk_add_f32 v[106:107], v[106:107], v[114:115]
    v_pk_add_f32 v[232:233], v[232:233], v[122:123]
    v_pk_add_f32 v[232:233], v[232:233], v[106:107]
    s_branch L_fin
L_rdy0:
    v_add_f32 v230, v230, v72
    v_add_f32 v76, v76, v80
    v_add_f32 v84, v84, v88
    v_add_f32 v92, v92, v96
    v_add_f32 v76, v76, v84
    v_pk_add_f32 v[232:233], v[232:233], v[74:75]
    v_add_f32 v230, v230, v92
    v_pk_add_f32 v[78:79], v[78:79], v[82:83]
    v_pk_add_f32 v[86:87], v[86:87], v[90:91]
    v_pk_add_f32 v[94:95], v[94:95], v[98:99]
    v_add_f32 v230, v230, v76
    v_pk_add_f32 v[78:79], v[78:79], v[86:87]
    v_pk_add_f32 v[232:233], v[232:233], v[94:95]
    v_pk_add_f32 v[232:233], v[232:233], v[78:79]
L_fin:
    v_cvt_pk_bf16_f32 v230, 0, v230
    v_fma_f32 v230, v230, s53, v4
    v_cvt_pk_bf16_f32 v232, 0, v232
    v_cvt_pk_bf16_f32 v233, 0, v233
    v_cvt_pk_bf16_f32 v230, 0, v230
    v_mul_f32 v232, s53, v232
    v_rcp_f32 v230, v230
    v_mul_f32 v233, s53, v233
    v_mul_f32 v232, v232, v230
    v_mul_f32 v233, v233, v230
    v_cvt_pk_bf16_f32 v232, v232, v233
    buffer_store_dword v232, v6, s[32:35], 0 offen
    s_mov_b64 exec, 1
    global_store_dword v246, v231, s[10:11]
    s_mov_b64 exec, -1
L_end:
    s_endpgm
.section .rodata,"a"
.p2align 6
.amdhsa_kernel standalone__linear_kernel_rfa__decode_kernel
  .amdhsa_next_free_vgpr 256
  .amdhsa_next_free_sgpr 102
  .amdhsa_accum_offset 256
  .amdhsa_group_segment_fixed_size 0
  .amdhsa_kernarg_size 56
  .amdhsa_user_sgpr_count 2
  .amdhsa_user_sgpr_kernarg_segment_ptr 1
  .amdhsa_system_sgpr_workgroup_id_x 1
  .amdhsa_float_denorm_mode_32 3
.end_amdhsa_kernel
```
